```python
import torch

def _softmax(x, axis=-1):
    return torch.softmax(x, dim=axis)
def _gelu(x):
    return torch.nn.functional.gelu(x, approximate="tanh")
def _silu(x):
    return torch.nn.functional.silu(x)
def _sigmoid(x):
    return torch.sigmoid(x)
def _layernorm(x, axis=-1, eps=1e-5):
    m = x.mean(dim=axis, keepdim=True)
    v = x.var(dim=axis, keepdim=True, unbiased=False)
    return (x - m) / torch.sqrt(v + eps)
def _scatter_add(tgt, idx, src, axis=0):
    return tgt.clone().index_add_(axis, idx, src)
def _segment_sum(src, seg, n):
    out = torch.zeros((n,) + src.shape[1:], dtype=src.dtype)
    return out.index_add_(0, seg, src)
def _pad(x, pw):
    flat = tuple(v for pair in reversed(pw) for v in pair)
    return torch.nn.functional.pad(x, flat)

kernel_name = 'standalone__structured_sparse_n_m__ragged'

def setup_inputs():

    _w = (lambda a: (lambda t: t.to(torch.bfloat16) if t.is_floating_point() else t)(torch.as_tensor(a)))
    B, S, D = 4, 2048, 640
    assert D % 4 == 0, "d_model must be divisible by M=4 for 2:4 sparsity"
    return {
        "x": _w((lambda *s: torch.randn(*s, dtype=torch.bfloat16) * 0.05)(B, S, D)),
        "w": _w((lambda *s: torch.randn(*s, dtype=torch.bfloat16) * 0.05)(D, D)),
        "b": _w((lambda *s: torch.randn(*s, dtype=torch.bfloat16) * 0.05)(D)),
    }

def reference(x, w, b):
    B, S, D = x.shape
    N, M = 2, 4
    G = D // M
    wg = w.reshape(G, M, D)
    mag = torch.abs(wg)
    order = torch.argsort(mag, 1)
    thr = (lambda x, i, axis: torch.take_along_dim(x, i, dim=axis))(mag, order[:, M - N:M - N + 1, :], 1)
    mask = (lambda x, dt: x.to(dt))(mag >= thr, w.dtype)
    wp = (wg * mask).reshape(D, D)
    return torch.einsum("bsd,df->bsf", x, wp) + b
```

```asm
; @launch grid=(240,1,1) block=(768,1,1) lds=161024
.amdgcn_target "amdgcn-amd-amdhsa--gfx950"
.text
.globl standalone__structured_sparse_n_m__ragged_kernel
.p2align 8
.type standalone__structured_sparse_n_m__ragged_kernel,@function
standalone__structured_sparse_n_m__ragged_kernel:
  s_load_dwordx4 s[4:7], s[0:1], 0
  s_load_dwordx4 s[8:11], s[0:1], 16
  v_lshrrev_b32 v1, 6, v0
  s_getpc_b64 s[76:77]
L_pc:
  s_bfe_u32 s56, s2, 0x30003
  s_mul_i32 s56, s56, 6144
  v_and_b32 v2, 3, v0
  v_lshl_add_u32 v2, v1, 2, v2
  v_lshlrev_b32 v2, 7, v2
  v_add_u32 v2, s56, v2
  v_min_u32 v2, L_last - L_pc, v2
  v_mov_b32 v3, s77
  v_add_co_u32 v2, vcc, s76, v2
  v_addc_co_u32 v3, vcc, 0, v3, vcc
  global_load_dword v167, v[2:3], off
  s_lshr_b32 s56, s2, 3
  s_and_b32 s58, s2, 7
  s_mul_i32 s57, s56, 205
  s_lshr_b32 s57, s57, 10
  v_readfirstlane_b32 s32, v1
  s_cmp_ge_u32 s2, 240
  s_cbranch_scc1 L_exit
  s_mul_i32 s59, s57, 5
  s_sub_u32 s33, s56, s59
  s_add_u32 s35, s33, s57
  s_sub_u32 s59, s35, 5
  s_cmp_ge_u32 s35, 5
  s_cselect_b32 s35, s59, s35
  s_cmp_eq_u32 s35, 5
  s_cselect_b32 s35, 0, s35
  s_lshl_b32 s35, s35, 7
  s_mov_b32 s36, s33
  s_mul_i32 s34, s58, 1310720
  s_mul_i32 s59, s57, 204800
  s_add_u32 s34, s34, s59
  s_min_u32 s59, s57, 2
  s_mul_i32 s59, s59, 40960
  s_add_u32 s34, s34, s59
  s_cmp_lt_u32 s57, 2
  s_cselect_b32 s3, 6, 5
  s_lshl_b32 s3, s3, 12
  s_cmp_lt_u32 s32, 4
  s_cbranch_scc1 L_cn
  s_cmp_ge_u32 s32, 8
  s_cbranch_scc1 L_bn
  s_setprio 1
  s_sub_u32 s39, s32, 4
  v_and_b32 v6, 63, v0
  v_lshrrev_b32 v24, 4, v6
  s_lshl_b32 s56, s39, 2
  v_add_u32 v24, s56, v24
  v_and_b32 v25, 15, v6
  v_mul_u32_u24 v9, 5120, v24
  v_lshl_add_u32 v1, v25, 4, v9
  s_lshl_b32 s59, s33, 8
  s_movk_i32 s57, 640
  s_mov_b32 s58, 0
  s_mov_b32 s40, s35
  s_mul_i32 s56, s40, 640
  s_add_u32 s80, s56, s59
  v_lshlrev_b32 v10, 2, v6
  s_waitcnt lgkmcnt(0)
  s_mov_b32 s20, s6
  s_and_b32 s21, s7, 0xffff
  s_mov_b32 s22, 819200
  s_mov_b32 s23, 0x20000
  buffer_load_dwordx4 v[32:35], v1, s[20:23], s80 offen offset:0
  buffer_load_dwordx4 v[36:39], v1, s[20:23], s80 offen offset:1280
  buffer_load_dwordx4 v[40:43], v1, s[20:23], s80 offen offset:2560
  buffer_load_dwordx4 v[44:47], v1, s[20:23], s80 offen offset:3840
  s_mov_b32 s28, s8
  s_and_b32 s29, s9, 0xffff
  s_mov_b32 s30, 1280
  s_mov_b32 s31, 0x20000
  buffer_load_dword v27, v10, s[28:31], s59 offen
  s_cmp_eq_u32 s3, 20480
  s_cbranch_scc1 L_a5
  s_branch L_a6
L_cn:
  v_and_b32 v1, 63, v0
  v_lshrrev_b32 v2, 3, v1
  s_lshl_b32 s56, s32, 3
  v_add_u32 v2, s56, v2
  v_lshrrev_b32 v3, 1, v2
  v_xor_b32 v3, v3, v1
  v_and_b32 v3, 7, v3
  v_mul_u32_u24 v2, 1280, v2
  v_lshl_add_u32 v153, v3, 4, v2
  s_lshl_b32 s37, s32, 10
  s_mul_i32 s50, s36, 40960
  s_add_u32 s50, s50, s34
  s_mul_i32 s57, s3, 10
  s_add_u32 s57, s57, s34
  s_add_u32 s51, s50, 40960
  s_cmp_eq_u32 s51, s57
  s_cselect_b32 s51, s34, s51
  s_add_u32 s52, s51, 40960
  s_cmp_eq_u32 s52, s57
  s_cselect_b32 s52, s34, s52
  s_add_u32 s53, s52, 40960
  s_cmp_eq_u32 s53, s57
  s_cselect_b32 s53, s34, s53
  s_add_u32 s54, s53, 40960
  s_cmp_eq_u32 s54, s57
  s_cselect_b32 s54, s34, s54
  s_add_u32 s55, s54, 40960
  s_cmp_eq_u32 s55, s57
  s_cselect_b32 s55, s34, s55
  s_movk_i32 s57, 640
  s_mov_b32 s58, 0
  s_mov_b32 s40, s35
  s_add_u32 s41, s40, 128
  s_cmp_eq_u32 s41, s57
  s_cselect_b32 s41, s58, s41
  s_add_u32 s31, s37, s3
  s_waitcnt lgkmcnt(0)
  s_mov_b32 s16, s4
  s_and_b32 s17, s5, 0xffff
  s_mov_b32 s18, 10485760
  s_mov_b32 s19, 0x20000
  s_add_u32 m0, s37, 0
  s_add_u32 s56, s50, s40
  buffer_load_dwordx4 v153, s[16:19], s56 offen  lds
  s_add_u32 m0, s37, 4096
  s_add_u32 s56, s51, s40
  buffer_load_dwordx4 v153, s[16:19], s56 offen  lds
  s_add_u32 m0, s37, 8192
  s_add_u32 s56, s52, s40
  buffer_load_dwordx4 v153, s[16:19], s56 offen  lds
  s_add_u32 m0, s37, 12288
  s_add_u32 s56, s53, s40
  buffer_load_dwordx4 v153, s[16:19], s56 offen  lds
  s_add_u32 m0, s37, 16384
  s_add_u32 s56, s54, s40
  buffer_load_dwordx4 v153, s[16:19], s56 offen  lds
  s_cmp_eq_u32 s3, 20480
  s_cbranch_scc1 L_n1
  s_add_u32 m0, s37, 20480
  s_add_u32 s56, s55, s40
  buffer_load_dwordx4 v153, s[16:19], s56 offen  lds
L_n1:
  s_add_u32 m0, s31, 0
  s_add_u32 s56, s50, s41
  buffer_load_dwordx4 v153, s[16:19], s56 offen  lds
  s_add_u32 m0, s31, 4096
  s_add_u32 s56, s51, s41
  buffer_load_dwordx4 v153, s[16:19], s56 offen  lds
  s_add_u32 m0, s31, 8192
  s_add_u32 s56, s52, s41
  buffer_load_dwordx4 v153, s[16:19], s56 offen  lds
  s_add_u32 m0, s31, 12288
  s_add_u32 s56, s53, s41
  buffer_load_dwordx4 v153, s[16:19], s56 offen  lds
  s_add_u32 m0, s31, 16384
  s_add_u32 s56, s54, s41
  buffer_load_dwordx4 v153, s[16:19], s56 offen  lds
  s_cmp_eq_u32 s3, 20480
  s_cbranch_scc1 L_c5
  s_add_u32 m0, s31, 20480
  s_add_u32 s56, s55, s41
  buffer_load_dwordx4 v153, s[16:19], s56 offen  lds
  s_branch L_c6
L_bn:
  s_sub_u32 s39, s32, 8
  v_and_b32 v6, 63, v0
  v_lshrrev_b32 v24, 4, v6
  s_lshl_b32 s56, s39, 2
  v_add_u32 v24, s56, v24
  v_and_b32 v25, 15, v6
  v_mul_u32_u24 v9, 5120, v24
  v_lshl_add_u32 v1, v25, 4, v9
  s_lshl_b32 s59, s33, 8
  s_movk_i32 s57, 640
  s_mov_b32 s58, 0
  s_mov_b32 s40, s35
  s_add_u32 s41, s40, 128
  s_cmp_eq_u32 s41, s57
  s_cselect_b32 s41, s58, s41
  s_mul_i32 s56, s41, 640
  s_add_u32 s80, s56, s59
  s_waitcnt lgkmcnt(0)
  s_mov_b32 s20, s6
  s_and_b32 s21, s7, 0xffff
  s_mov_b32 s22, 819200
  s_mov_b32 s23, 0x20000
  buffer_load_dwordx4 v[32:35], v1, s[20:23], s80 offen offset:0
  buffer_load_dwordx4 v[36:39], v1, s[20:23], s80 offen offset:1280
  buffer_load_dwordx4 v[40:43], v1, s[20:23], s80 offen offset:2560
  buffer_load_dwordx4 v[44:47], v1, s[20:23], s80 offen offset:3840
  s_cmp_eq_u32 s3, 20480
  s_cbranch_scc1 L_b5
  s_branch L_b6
L_exit:
  s_endpgm
L_a6:
  s_movk_i32 s57, 640
  s_mov_b32 s58, 0
  s_add_u32 s41, s40, 128
  s_cmp_eq_u32 s41, s57
  s_cselect_b32 s41, s58, s41
  s_add_u32 s42, s41, 128
  s_cmp_eq_u32 s42, s57
  s_cselect_b32 s42, s58, s42
  s_add_u32 s43, s42, 128
  s_cmp_eq_u32 s43, s57
  s_cselect_b32 s43, s58, s43
  s_add_u32 s44, s43, 128
  s_cmp_eq_u32 s44, s57
  s_cselect_b32 s44, s58, s44
  s_add_u32 s45, s40, 640
  s_add_u32 s46, s41, 640
  s_add_u32 s47, s42, 640
  s_add_u32 s48, s43, 640
  s_add_u32 s49, s44, 640
  s_mul_i32 s56, s42, 640
  s_add_u32 s81, s56, s59
  s_mul_i32 s56, s44, 640
  s_add_u32 s82, s56, s59
  s_mul_i32 s56, s46, 640
  s_add_u32 s83, s56, s59
  s_mul_i32 s56, s48, 640
  s_add_u32 s84, s56, s59
  s_mov_b32 s38, 0x7fff7fff
  s_mov_b32 s16, s4
  s_and_b32 s17, s5, 0xffff
  s_mov_b32 s18, 10485760
  s_mov_b32 s19, 0x20000
  v_lshrrev_b32 v12, 3, v6
  s_lshl_b32 s56, s39, 3
  v_add_u32 v12, s56, v12
  v_lshrrev_b32 v13, 1, v12
  v_xor_b32 v13, v13, v6
  v_and_b32 v13, 7, v13
  v_mul_u32_u24 v12, 1280, v12
  v_lshl_add_u32 v7, v13, 4, v12
  s_lshl_b32 s37, s39, 10
  s_mul_i32 s50, s36, 40960
  s_add_u32 s50, s50, s34
  s_add_u32 s57, s34, 245760
  s_add_u32 s51, s50, 40960
  s_cmp_eq_u32 s51, s57
  s_cselect_b32 s51, s34, s51
  s_add_u32 s52, s51, 40960
  s_cmp_eq_u32 s52, s57
  s_cselect_b32 s52, s34, s52
  s_add_u32 s53, s52, 40960
  s_cmp_eq_u32 s53, s57
  s_cselect_b32 s53, s34, s53
  s_add_u32 s54, s53, 40960
  s_cmp_eq_u32 s54, s57
  s_cselect_b32 s54, s34, s54
  s_add_u32 s55, s54, 40960
  s_cmp_eq_u32 s55, s57
  s_cselect_b32 s55, s34, s55
  s_add_u32 s90, s50, s59
  s_add_u32 s91, s51, s59
  s_add_u32 s92, s52, s59
  s_add_u32 s93, s53, s59
  s_add_u32 s94, s54, s59
  s_add_u32 s95, s55, s59
  s_mov_b32 s24, s10
  s_and_b32 s25, s11, 0xffff
  s_mov_b32 s26, 10485760
  s_mov_b32 s27, 0x20000
  v_lshrrev_b32 v9, 2, v25
  v_mul_u32_u24 v9, 4160, v9
  v_lshl_add_u32 v14, v24, 8, v9
  v_and_b32 v12, 3, v25
  v_lshl_add_u32 v14, v12, 4, v14
  v_add_u32 v2, 126976, v14
  v_lshrrev_b32 v13, 4, v6
  s_lshl_b32 s56, s39, 3
  v_add_u32 v13, s56, v13
  v_lshrrev_b32 v14, 1, v13
  v_xor_b32 v14, v14, v12
  v_and_b32 v14, 3, v14
  v_lshlrev_b32 v14, 4, v14
  v_lshl_add_u32 v14, v13, 6, v14
  v_add_u32 v14, v14, v9
  v_add_u32 v3, 126976, v14
  v_mul_u32_u24 v13, 1280, v13
  v_lshl_add_u32 v4, v25, 4, v13
  v_lshlrev_b32 v26, 3, v6
  v_add_u32 v26, 160256, v26
  v_mov_b32 v5, 160768
  s_mov_b32 s3, 0x01010101
  s_waitcnt vmcnt(1)
  buffer_load_dwordx4 v[48:51], v1, s[20:23], s81 offen offset:0
  v_and_b32 v8, s38, v32
  v_and_b32 v16, s38, v33
  v_and_b32 v9, s38, v36
  v_and_b32 v17, s38, v37
  v_and_b32 v10, s38, v40
  v_and_b32 v18, s38, v41
  v_and_b32 v11, s38, v44
  v_and_b32 v19, s38, v45
  v_pk_max_u16 v12, v8, v9
  v_pk_max_u16 v20, v16, v17
  v_pk_min_u16 v13, v8, v9
  v_pk_min_u16 v21, v16, v17
  v_pk_max_u16 v14, v10, v11
  v_pk_max_u16 v22, v18, v19
  v_pk_min_u16 v15, v10, v11
  v_pk_min_u16 v23, v18, v19
  v_pk_min_u16 v12, v12, v14
  v_pk_min_u16 v20, v20, v22
  v_pk_max_u16 v13, v13, v15
  v_pk_max_u16 v21, v21, v23
  v_pk_max_u16 v12, v12, v13
  v_pk_max_u16 v20, v20, v21
  v_pk_sub_i16 v8, v8, v12
  buffer_load_dwordx4 v[52:55], v1, s[20:23], s81 offen offset:1280
  v_pk_sub_i16 v16, v16, v20
  v_pk_sub_i16 v9, v9, v12
  v_pk_sub_i16 v17, v17, v20
  v_pk_sub_i16 v10, v10, v12
  v_pk_sub_i16 v18, v18, v20
  v_pk_sub_i16 v11, v11, v12
  v_pk_sub_i16 v19, v19, v20
  v_pk_ashrrev_i16 v8, 15, v8 op_sel_hi:[0,1]
  v_pk_ashrrev_i16 v16, 15, v16 op_sel_hi:[0,1]
  v_pk_ashrrev_i16 v9, 15, v9 op_sel_hi:[0,1]
  v_pk_ashrrev_i16 v17, 15, v17 op_sel_hi:[0,1]
  v_pk_ashrrev_i16 v10, 15, v10 op_sel_hi:[0,1]
  v_pk_ashrrev_i16 v18, 15, v18 op_sel_hi:[0,1]
  v_pk_ashrrev_i16 v11, 15, v11 op_sel_hi:[0,1]
  v_pk_ashrrev_i16 v19, 15, v19 op_sel_hi:[0,1]
  v_bfi_b32 v32, v8, 0, v32
  v_bfi_b32 v33, v16, 0, v33
  v_bfi_b32 v36, v9, 0, v36
  v_bfi_b32 v37, v17, 0, v37
  v_bfi_b32 v40, v10, 0, v40
  v_bfi_b32 v41, v18, 0, v41
  v_bfi_b32 v44, v11, 0, v44
  v_bfi_b32 v45, v19, 0, v45
  buffer_load_dwordx4 v[56:59], v1, s[20:23], s81 offen offset:2560
  v_and_b32 v8, s38, v34
  v_and_b32 v16, s38, v35
  v_and_b32 v9, s38, v38
  v_and_b32 v17, s38, v39
  v_and_b32 v10, s38, v42
  v_and_b32 v18, s38, v43
  v_and_b32 v11, s38, v46
  v_and_b32 v19, s38, v47
  v_pk_max_u16 v12, v8, v9
  v_pk_max_u16 v20, v16, v17
  v_pk_min_u16 v13, v8, v9
  v_pk_min_u16 v21, v16, v17
  v_pk_max_u16 v14, v10, v11
  v_pk_max_u16 v22, v18, v19
  v_pk_min_u16 v15, v10, v11
  v_pk_min_u16 v23, v18, v19
  v_pk_min_u16 v12, v12, v14
  v_pk_min_u16 v20, v20, v22
  v_pk_max_u16 v13, v13, v15
  v_pk_max_u16 v21, v21, v23
  v_pk_max_u16 v12, v12, v13
  v_pk_max_u16 v20, v20, v21
  v_pk_sub_i16 v8, v8, v12
  buffer_load_dwordx4 v[60:63], v1, s[20:23], s81 offen offset:3840
  v_pk_sub_i16 v16, v16, v20
  v_pk_sub_i16 v9, v9, v12
  v_pk_sub_i16 v17, v17, v20
  v_pk_sub_i16 v10, v10, v12
  v_pk_sub_i16 v18, v18, v20
  v_pk_sub_i16 v11, v11, v12
  v_pk_sub_i16 v19, v19, v20
  v_pk_ashrrev_i16 v8, 15, v8 op_sel_hi:[0,1]
  v_pk_ashrrev_i16 v16, 15, v16 op_sel_hi:[0,1]
  v_pk_ashrrev_i16 v9, 15, v9 op_sel_hi:[0,1]
  v_pk_ashrrev_i16 v17, 15, v17 op_sel_hi:[0,1]
  v_pk_ashrrev_i16 v10, 15, v10 op_sel_hi:[0,1]
  v_pk_ashrrev_i16 v18, 15, v18 op_sel_hi:[0,1]
  v_pk_ashrrev_i16 v11, 15, v11 op_sel_hi:[0,1]
  v_pk_ashrrev_i16 v19, 15, v19 op_sel_hi:[0,1]
  v_bfi_b32 v34, v8, 0, v34
  v_bfi_b32 v35, v16, 0, v35
  v_bfi_b32 v38, v9, 0, v38
  v_bfi_b32 v39, v17, 0, v39
  v_bfi_b32 v42, v10, 0, v42
  v_bfi_b32 v43, v18, 0, v43
  v_bfi_b32 v46, v11, 0, v46
  v_bfi_b32 v47, v19, 0, v47
  ds_write_b128 v2, v[32:35] offset:0
  ds_write_b128 v2, v[36:39] offset:64
  ds_write_b128 v2, v[40:43] offset:128
  ds_write_b128 v2, v[44:47] offset:192
  s_waitcnt vmcnt(4)
  v_lshlrev_b32 v28, 16, v27
  v_and_b32 v29, 0xffff0000, v27
  ds_write_b64 v26, v[28:29]
  s_setprio 0
  s_waitcnt lgkmcnt(0)
  s_barrier
  s_waitcnt vmcnt(0)
  buffer_load_dwordx4 v[32:35], v1, s[20:23], s82 offen offset:0
  v_and_b32 v8, s38, v48
  v_and_b32 v16, s38, v49
  v_and_b32 v9, s38, v52
  v_and_b32 v17, s38, v53
  v_and_b32 v10, s38, v56
  v_and_b32 v18, s38, v57
  v_and_b32 v11, s38, v60
  v_and_b32 v19, s38, v61
  v_pk_max_u16 v12, v8, v9
  v_pk_max_u16 v20, v16, v17
  v_pk_min_u16 v13, v8, v9
  v_pk_min_u16 v21, v16, v17
  v_pk_max_u16 v14, v10, v11
  v_pk_max_u16 v22, v18, v19
  v_pk_min_u16 v15, v10, v11
  v_pk_min_u16 v23, v18, v19
  v_pk_min_u16 v12, v12, v14
  v_pk_min_u16 v20, v20, v22
  v_pk_max_u16 v13, v13, v15
  v_pk_max_u16 v21, v21, v23
  buffer_load_dwordx4 v[36:39], v1, s[20:23], s82 offen offset:1280
  v_pk_max_u16 v12, v12, v13
  v_pk_max_u16 v20, v20, v21
  v_pk_sub_i16 v8, v8, v12
  v_pk_sub_i16 v16, v16, v20
  v_pk_sub_i16 v9, v9, v12
  v_pk_sub_i16 v17, v17, v20
  v_pk_sub_i16 v10, v10, v12
  v_pk_sub_i16 v18, v18, v20
  v_pk_sub_i16 v11, v11, v12
  v_pk_sub_i16 v19, v19, v20
  v_pk_ashrrev_i16 v8, 15, v8 op_sel_hi:[0,1]
  v_pk_ashrrev_i16 v16, 15, v16 op_sel_hi:[0,1]
  v_pk_ashrrev_i16 v9, 15, v9 op_sel_hi:[0,1]
  v_pk_ashrrev_i16 v17, 15, v17 op_sel_hi:[0,1]
  v_pk_ashrrev_i16 v10, 15, v10 op_sel_hi:[0,1]
  v_pk_ashrrev_i16 v18, 15, v18 op_sel_hi:[0,1]
  v_pk_ashrrev_i16 v11, 15, v11 op_sel_hi:[0,1]
  v_pk_ashrrev_i16 v19, 15, v19 op_sel_hi:[0,1]
  v_bfi_b32 v48, v8, 0, v48
  buffer_load_dwordx4 v[40:43], v1, s[20:23], s82 offen offset:2560
  v_bfi_b32 v49, v16, 0, v49
  v_bfi_b32 v52, v9, 0, v52
  v_bfi_b32 v53, v17, 0, v53
  v_bfi_b32 v56, v10, 0, v56
  v_bfi_b32 v57, v18, 0, v57
  v_bfi_b32 v60, v11, 0, v60
  v_bfi_b32 v61, v19, 0, v61
  v_and_b32 v8, s38, v50
  v_and_b32 v16, s38, v51
  v_and_b32 v9, s38, v54
  v_and_b32 v17, s38, v55
  v_and_b32 v10, s38, v58
  v_and_b32 v18, s38, v59
  v_and_b32 v11, s38, v62
  v_and_b32 v19, s38, v63
  v_pk_max_u16 v12, v8, v9
  v_pk_max_u16 v20, v16, v17
  v_pk_min_u16 v13, v8, v9
  v_pk_min_u16 v21, v16, v17
  v_pk_max_u16 v14, v10, v11
  buffer_load_dwordx4 v[44:47], v1, s[20:23], s82 offen offset:3840
  v_pk_max_u16 v22, v18, v19
  v_pk_min_u16 v15, v10, v11
  v_pk_min_u16 v23, v18, v19
  v_pk_min_u16 v12, v12, v14
  v_pk_min_u16 v20, v20, v22
  v_pk_max_u16 v13, v13, v15
  v_pk_max_u16 v21, v21, v23
  v_pk_max_u16 v12, v12, v13
  v_pk_max_u16 v20, v20, v21
  v_pk_sub_i16 v8, v8, v12
  v_pk_sub_i16 v16, v16, v20
  v_pk_sub_i16 v9, v9, v12
  v_pk_sub_i16 v17, v17, v20
  v_pk_sub_i16 v10, v10, v12
  v_pk_sub_i16 v18, v18, v20
  v_pk_sub_i16 v11, v11, v12
  v_pk_sub_i16 v19, v19, v20
  v_pk_ashrrev_i16 v8, 15, v8 op_sel_hi:[0,1]
  v_pk_ashrrev_i16 v16, 15, v16 op_sel_hi:[0,1]
  s_waitcnt lgkmcnt(0)
  s_barrier
  s_setprio 1
  v_pk_ashrrev_i16 v9, 15, v9 op_sel_hi:[0,1]
  v_pk_ashrrev_i16 v17, 15, v17 op_sel_hi:[0,1]
  v_pk_ashrrev_i16 v10, 15, v10 op_sel_hi:[0,1]
  v_pk_ashrrev_i16 v18, 15, v18 op_sel_hi:[0,1]
  v_pk_ashrrev_i16 v11, 15, v11 op_sel_hi:[0,1]
  v_pk_ashrrev_i16 v19, 15, v19 op_sel_hi:[0,1]
  v_bfi_b32 v50, v8, 0, v50
  v_bfi_b32 v51, v16, 0, v51
  v_bfi_b32 v54, v9, 0, v54
  v_bfi_b32 v55, v17, 0, v55
  v_bfi_b32 v58, v10, 0, v58
  v_bfi_b32 v59, v18, 0, v59
  v_bfi_b32 v62, v11, 0, v62
  v_bfi_b32 v63, v19, 0, v63
  ds_write_b128 v2, v[48:51] offset:0
  s_add_u32 m0, s37, 73728
  s_add_u32 s56, s50, s43
  buffer_load_dwordx4 v7, s[16:19], s56 offen  lds
  ds_write_b128 v2, v[52:55] offset:64
  s_add_u32 m0, s37, 77824
  s_add_u32 s56, s51, s43
  buffer_load_dwordx4 v7, s[16:19], s56 offen  lds
  ds_write_b128 v2, v[56:59] offset:128
  s_add_u32 m0, s37, 81920
  s_add_u32 s56, s52, s43
  buffer_load_dwordx4 v7, s[16:19], s56 offen  lds
  ds_write_b128 v2, v[60:63] offset:192
  s_add_u32 m0, s37, 86016
  s_add_u32 s56, s53, s43
  buffer_load_dwordx4 v7, s[16:19], s56 offen  lds
  s_setprio 0
  s_add_u32 m0, s37, 90112
  s_add_u32 s56, s54, s43
  buffer_load_dwordx4 v7, s[16:19], s56 offen  lds
  s_add_u32 m0, s37, 94208
  s_add_u32 s56, s55, s43
  buffer_load_dwordx4 v7, s[16:19], s56 offen  lds
  s_waitcnt lgkmcnt(0)
  s_barrier
  s_waitcnt vmcnt(6)
  buffer_load_dwordx4 v[48:51], v1, s[20:23], s83 offen offset:0
  v_and_b32 v8, s38, v32
  v_and_b32 v16, s38, v33
  v_and_b32 v9, s38, v36
  v_and_b32 v17, s38, v37
  v_and_b32 v10, s38, v40
  v_and_b32 v18, s38, v41
  v_and_b32 v11, s38, v44
  v_and_b32 v19, s38, v45
  v_pk_max_u16 v12, v8, v9
  v_pk_max_u16 v20, v16, v17
  v_pk_min_u16 v13, v8, v9
  v_pk_min_u16 v21, v16, v17
  v_pk_max_u16 v14, v10, v11
  v_pk_max_u16 v22, v18, v19
  v_pk_min_u16 v15, v10, v11
  v_pk_min_u16 v23, v18, v19
  v_pk_min_u16 v12, v12, v14
  v_pk_min_u16 v20, v20, v22
  v_pk_max_u16 v13, v13, v15
  v_pk_max_u16 v21, v21, v23
  buffer_load_dwordx4 v[52:55], v1, s[20:23], s83 offen offset:1280
  v_pk_max_u16 v12, v12, v13
  v_pk_max_u16 v20, v20, v21
  v_pk_sub_i16 v8, v8, v12
  v_pk_sub_i16 v16, v16, v20
  v_pk_sub_i16 v9, v9, v12
  v_pk_sub_i16 v17, v17, v20
  v_pk_sub_i16 v10, v10, v12
  v_pk_sub_i16 v18, v18, v20
  v_pk_sub_i16 v11, v11, v12
  v_pk_sub_i16 v19, v19, v20
  v_pk_ashrrev_i16 v8, 15, v8 op_sel_hi:[0,1]
  v_pk_ashrrev_i16 v16, 15, v16 op_sel_hi:[0,1]
  v_pk_ashrrev_i16 v9, 15, v9 op_sel_hi:[0,1]
  v_pk_ashrrev_i16 v17, 15, v17 op_sel_hi:[0,1]
  v_pk_ashrrev_i16 v10, 15, v10 op_sel_hi:[0,1]
  v_pk_ashrrev_i16 v18, 15, v18 op_sel_hi:[0,1]
  v_pk_ashrrev_i16 v11, 15, v11 op_sel_hi:[0,1]
  v_pk_ashrrev_i16 v19, 15, v19 op_sel_hi:[0,1]
  v_bfi_b32 v32, v8, 0, v32
  buffer_load_dwordx4 v[56:59], v1, s[20:23], s83 offen offset:2560
  v_bfi_b32 v33, v16, 0, v33
  v_bfi_b32 v36, v9, 0, v36
  v_bfi_b32 v37, v17, 0, v37
  v_bfi_b32 v40, v10, 0, v40
  v_bfi_b32 v41, v18, 0, v41
  v_bfi_b32 v44, v11, 0, v44
  v_bfi_b32 v45, v19, 0, v45
  v_and_b32 v8, s38, v34
  v_and_b32 v16, s38, v35
  v_and_b32 v9, s38, v38
  v_and_b32 v17, s38, v39
  v_and_b32 v10, s38, v42
  v_and_b32 v18, s38, v43
  v_and_b32 v11, s38, v46
  v_and_b32 v19, s38, v47
  v_pk_max_u16 v12, v8, v9
  v_pk_max_u16 v20, v16, v17
  v_pk_min_u16 v13, v8, v9
  v_pk_min_u16 v21, v16, v17
  v_pk_max_u16 v14, v10, v11
  buffer_load_dwordx4 v[60:63], v1, s[20:23], s83 offen offset:3840
  v_pk_max_u16 v22, v18, v19
  v_pk_min_u16 v15, v10, v11
  v_pk_min_u16 v23, v18, v19
  v_pk_min_u16 v12, v12, v14
  v_pk_min_u16 v20, v20, v22
  v_pk_max_u16 v13, v13, v15
  v_pk_max_u16 v21, v21, v23
  v_pk_max_u16 v12, v12, v13
  v_pk_max_u16 v20, v20, v21
  v_pk_sub_i16 v8, v8, v12
  v_pk_sub_i16 v16, v16, v20
  v_pk_sub_i16 v9, v9, v12
  v_pk_sub_i16 v17, v17, v20
  v_pk_sub_i16 v10, v10, v12
  v_pk_sub_i16 v18, v18, v20
  v_pk_sub_i16 v11, v11, v12
  v_pk_sub_i16 v19, v19, v20
  v_pk_ashrrev_i16 v8, 15, v8 op_sel_hi:[0,1]
  v_pk_ashrrev_i16 v16, 15, v16 op_sel_hi:[0,1]
  s_waitcnt vmcnt(4)
  s_waitcnt lgkmcnt(0)
  s_barrier
  s_setprio 1
  v_pk_ashrrev_i16 v9, 15, v9 op_sel_hi:[0,1]
  v_pk_ashrrev_i16 v17, 15, v17 op_sel_hi:[0,1]
  v_pk_ashrrev_i16 v10, 15, v10 op_sel_hi:[0,1]
  v_pk_ashrrev_i16 v18, 15, v18 op_sel_hi:[0,1]
  v_pk_ashrrev_i16 v11, 15, v11 op_sel_hi:[0,1]
  v_pk_ashrrev_i16 v19, 15, v19 op_sel_hi:[0,1]
  v_bfi_b32 v34, v8, 0, v34
  v_bfi_b32 v35, v16, 0, v35
  v_bfi_b32 v38, v9, 0, v38
  v_bfi_b32 v39, v17, 0, v39
  v_bfi_b32 v42, v10, 0, v42
  v_bfi_b32 v43, v18, 0, v43
  v_bfi_b32 v46, v11, 0, v46
  v_bfi_b32 v47, v19, 0, v47
  ds_write_b128 v2, v[32:35] offset:0
  s_add_u32 m0, s37, 122880
  s_add_u32 s56, s50, s45
  buffer_load_dwordx4 v7, s[16:19], s56 offen  lds
  ds_write_b128 v2, v[36:39] offset:64
  s_add_u32 m0, s37, 0
  s_add_u32 s56, s51, s45
  buffer_load_dwordx4 v7, s[16:19], s56 offen  lds
  ds_write_b128 v2, v[40:43] offset:128
  s_add_u32 m0, s37, 4096
  s_add_u32 s56, s52, s45
  buffer_load_dwordx4 v7, s[16:19], s56 offen  lds
  ds_write_b128 v2, v[44:47] offset:192
  s_add_u32 m0, s37, 8192
  s_add_u32 s56, s53, s45
  buffer_load_dwordx4 v7, s[16:19], s56 offen  lds
  s_setprio 0
  s_add_u32 m0, s37, 12288
  s_add_u32 s56, s54, s45
  buffer_load_dwordx4 v7, s[16:19], s56 offen  lds
  s_add_u32 m0, s37, 16384
  s_add_u32 s56, s55, s45
  buffer_load_dwordx4 v7, s[16:19], s56 offen  lds
  s_waitcnt lgkmcnt(0)
  s_barrier
  s_waitcnt vmcnt(6)
  buffer_load_dwordx4 v[32:35], v1, s[20:23], s84 offen offset:0
  v_and_b32 v8, s38, v48
  v_and_b32 v16, s38, v49
  v_and_b32 v9, s38, v52
  v_and_b32 v17, s38, v53
  v_and_b32 v10, s38, v56
  v_and_b32 v18, s38, v57
  v_and_b32 v11, s38, v60
  v_and_b32 v19, s38, v61
  v_pk_max_u16 v12, v8, v9
  v_pk_max_u16 v20, v16, v17
  v_pk_min_u16 v13, v8, v9
  v_pk_min_u16 v21, v16, v17
  v_pk_max_u16 v14, v10, v11
  v_pk_max_u16 v22, v18, v19
  v_pk_min_u16 v15, v10, v11
  v_pk_min_u16 v23, v18, v19
  v_pk_min_u16 v12, v12, v14
  v_pk_min_u16 v20, v20, v22
  v_pk_max_u16 v13, v13, v15
  v_pk_max_u16 v21, v21, v23
  buffer_load_dwordx4 v[36:39], v1, s[20:23], s84 offen offset:1280
  v_pk_max_u16 v12, v12, v13
  v_pk_max_u16 v20, v20, v21
  v_pk_sub_i16 v8, v8, v12
  v_pk_sub_i16 v16, v16, v20
  v_pk_sub_i16 v9, v9, v12
  v_pk_sub_i16 v17, v17, v20
  v_pk_sub_i16 v10, v10, v12
  v_pk_sub_i16 v18, v18, v20
  v_pk_sub_i16 v11, v11, v12
  v_pk_sub_i16 v19, v19, v20
  v_pk_ashrrev_i16 v8, 15, v8 op_sel_hi:[0,1]
  v_pk_ashrrev_i16 v16, 15, v16 op_sel_hi:[0,1]
  v_pk_ashrrev_i16 v9, 15, v9 op_sel_hi:[0,1]
  v_pk_ashrrev_i16 v17, 15, v17 op_sel_hi:[0,1]
  v_pk_ashrrev_i16 v10, 15, v10 op_sel_hi:[0,1]
  v_pk_ashrrev_i16 v18, 15, v18 op_sel_hi:[0,1]
  v_pk_ashrrev_i16 v11, 15, v11 op_sel_hi:[0,1]
  v_pk_ashrrev_i16 v19, 15, v19 op_sel_hi:[0,1]
  v_bfi_b32 v48, v8, 0, v48
  buffer_load_dwordx4 v[40:43], v1, s[20:23], s84 offen offset:2560
  v_bfi_b32 v49, v16, 0, v49
  v_bfi_b32 v52, v9, 0, v52
  v_bfi_b32 v53, v17, 0, v53
  v_bfi_b32 v56, v10, 0, v56
  v_bfi_b32 v57, v18, 0, v57
  v_bfi_b32 v60, v11, 0, v60
  v_bfi_b32 v61, v19, 0, v61
  v_and_b32 v8, s38, v50
  v_and_b32 v16, s38, v51
  v_and_b32 v9, s38, v54
  v_and_b32 v17, s38, v55
  v_and_b32 v10, s38, v58
  v_and_b32 v18, s38, v59
  v_and_b32 v11, s38, v62
  v_and_b32 v19, s38, v63
  v_pk_max_u16 v12, v8, v9
  v_pk_max_u16 v20, v16, v17
  v_pk_min_u16 v13, v8, v9
  v_pk_min_u16 v21, v16, v17
  v_pk_max_u16 v14, v10, v11
  buffer_load_dwordx4 v[44:47], v1, s[20:23], s84 offen offset:3840
  v_pk_max_u16 v22, v18, v19
  v_pk_min_u16 v15, v10, v11
  v_pk_min_u16 v23, v18, v19
  v_pk_min_u16 v12, v12, v14
  v_pk_min_u16 v20, v20, v22
  v_pk_max_u16 v13, v13, v15
  v_pk_max_u16 v21, v21, v23
  v_pk_max_u16 v12, v12, v13
  v_pk_max_u16 v20, v20, v21
  v_pk_sub_i16 v8, v8, v12
  v_pk_sub_i16 v16, v16, v20
  v_pk_sub_i16 v9, v9, v12
  v_pk_sub_i16 v17, v17, v20
  v_pk_sub_i16 v10, v10, v12
  v_pk_sub_i16 v18, v18, v20
  v_pk_sub_i16 v11, v11, v12
  v_pk_sub_i16 v19, v19, v20
  v_pk_ashrrev_i16 v8, 15, v8 op_sel_hi:[0,1]
  v_pk_ashrrev_i16 v16, 15, v16 op_sel_hi:[0,1]
  s_waitcnt vmcnt(4)
  s_waitcnt lgkmcnt(0)
  s_barrier
  s_setprio 1
  v_pk_ashrrev_i16 v9, 15, v9 op_sel_hi:[0,1]
  v_pk_ashrrev_i16 v17, 15, v17 op_sel_hi:[0,1]
  v_pk_ashrrev_i16 v10, 15, v10 op_sel_hi:[0,1]
  v_pk_ashrrev_i16 v18, 15, v18 op_sel_hi:[0,1]
  v_pk_ashrrev_i16 v11, 15, v11 op_sel_hi:[0,1]
  v_pk_ashrrev_i16 v19, 15, v19 op_sel_hi:[0,1]
  v_bfi_b32 v50, v8, 0, v50
  v_bfi_b32 v51, v16, 0, v51
  v_bfi_b32 v54, v9, 0, v54
  v_bfi_b32 v55, v17, 0, v55
  v_bfi_b32 v58, v10, 0, v58
  v_bfi_b32 v59, v18, 0, v59
  v_bfi_b32 v62, v11, 0, v62
  v_bfi_b32 v63, v19, 0, v63
  ds_write_b128 v2, v[48:51] offset:0
  s_add_u32 m0, s37, 45056
  s_add_u32 s56, s50, s47
  buffer_load_dwordx4 v7, s[16:19], s56 offen  lds
  ds_write_b128 v2, v[52:55] offset:64
  s_add_u32 m0, s37, 49152
  s_add_u32 s56, s51, s47
  buffer_load_dwordx4 v7, s[16:19], s56 offen  lds
  ds_write_b128 v2, v[56:59] offset:128
  s_add_u32 m0, s37, 53248
  s_add_u32 s56, s52, s47
  buffer_load_dwordx4 v7, s[16:19], s56 offen  lds
  ds_write_b128 v2, v[60:63] offset:192
  s_add_u32 m0, s37, 57344
  s_add_u32 s56, s53, s47
  buffer_load_dwordx4 v7, s[16:19], s56 offen  lds
  s_setprio 0
  s_add_u32 m0, s37, 61440
  s_add_u32 s56, s54, s47
  buffer_load_dwordx4 v7, s[16:19], s56 offen  lds
  s_add_u32 m0, s37, 65536
  s_add_u32 s56, s55, s47
  buffer_load_dwordx4 v7, s[16:19], s56 offen  lds
  s_waitcnt lgkmcnt(0)
  s_barrier
  s_waitcnt vmcnt(6)
  v_and_b32 v8, s38, v32
  v_and_b32 v16, s38, v33
  v_and_b32 v9, s38, v36
  v_and_b32 v17, s38, v37
  v_and_b32 v10, s38, v40
  v_and_b32 v18, s38, v41
  v_and_b32 v11, s38, v44
  v_and_b32 v19, s38, v45
  v_pk_max_u16 v12, v8, v9
  v_pk_max_u16 v20, v16, v17
  v_pk_min_u16 v13, v8, v9
  v_pk_min_u16 v21, v16, v17
  v_pk_max_u16 v14, v10, v11
  v_pk_max_u16 v22, v18, v19
  v_pk_min_u16 v15, v10, v11
  v_pk_min_u16 v23, v18, v19
  v_pk_min_u16 v12, v12, v14
  v_pk_min_u16 v20, v20, v22
  v_pk_max_u16 v13, v13, v15
  v_pk_max_u16 v21, v21, v23
  v_pk_max_u16 v12, v12, v13
  v_pk_max_u16 v20, v20, v21
  v_pk_sub_i16 v8, v8, v12
  v_pk_sub_i16 v16, v16, v20
  v_pk_sub_i16 v9, v9, v12
  v_pk_sub_i16 v17, v17, v20
  v_pk_sub_i16 v10, v10, v12
  v_pk_sub_i16 v18, v18, v20
  v_pk_sub_i16 v11, v11, v12
  v_pk_sub_i16 v19, v19, v20
  v_pk_ashrrev_i16 v8, 15, v8 op_sel_hi:[0,1]
  v_pk_ashrrev_i16 v16, 15, v16 op_sel_hi:[0,1]
  v_pk_ashrrev_i16 v9, 15, v9 op_sel_hi:[0,1]
  v_pk_ashrrev_i16 v17, 15, v17 op_sel_hi:[0,1]
  v_pk_ashrrev_i16 v10, 15, v10 op_sel_hi:[0,1]
  v_pk_ashrrev_i16 v18, 15, v18 op_sel_hi:[0,1]
  v_pk_ashrrev_i16 v11, 15, v11 op_sel_hi:[0,1]
  v_pk_ashrrev_i16 v19, 15, v19 op_sel_hi:[0,1]
  v_bfi_b32 v32, v8, 0, v32
  v_bfi_b32 v33, v16, 0, v33
  v_bfi_b32 v36, v9, 0, v36
  v_bfi_b32 v37, v17, 0, v37
  v_bfi_b32 v40, v10, 0, v40
  v_bfi_b32 v41, v18, 0, v41
  v_bfi_b32 v44, v11, 0, v44
  v_bfi_b32 v45, v19, 0, v45
  v_and_b32 v8, s38, v34
  v_and_b32 v16, s38, v35
  v_and_b32 v9, s38, v38
  v_and_b32 v17, s38, v39
  v_and_b32 v10, s38, v42
  v_and_b32 v18, s38, v43
  v_and_b32 v11, s38, v46
  v_and_b32 v19, s38, v47
  v_pk_max_u16 v12, v8, v9
  v_pk_max_u16 v20, v16, v17
  v_pk_min_u16 v13, v8, v9
  v_pk_min_u16 v21, v16, v17
  v_pk_max_u16 v14, v10, v11
  v_pk_max_u16 v22, v18, v19
  v_pk_min_u16 v15, v10, v11
  v_pk_min_u16 v23, v18, v19
  v_pk_min_u16 v12, v12, v14
  v_pk_min_u16 v20, v20, v22
  v_pk_max_u16 v13, v13, v15
  v_pk_max_u16 v21, v21, v23
  v_pk_max_u16 v12, v12, v13
  v_pk_max_u16 v20, v20, v21
  v_pk_sub_i16 v8, v8, v12
  v_pk_sub_i16 v16, v16, v20
  v_pk_sub_i16 v9, v9, v12
  v_pk_sub_i16 v17, v17, v20
  v_pk_sub_i16 v10, v10, v12
  v_pk_sub_i16 v18, v18, v20
  v_pk_sub_i16 v11, v11, v12
  v_pk_sub_i16 v19, v19, v20
  v_pk_ashrrev_i16 v8, 15, v8 op_sel_hi:[0,1]
  v_pk_ashrrev_i16 v16, 15, v16 op_sel_hi:[0,1]
  s_waitcnt vmcnt(0)
  s_waitcnt lgkmcnt(0)
  s_barrier
  s_setprio 1
  v_pk_ashrrev_i16 v9, 15, v9 op_sel_hi:[0,1]
  v_pk_ashrrev_i16 v17, 15, v17 op_sel_hi:[0,1]
  v_pk_ashrrev_i16 v10, 15, v10 op_sel_hi:[0,1]
  v_pk_ashrrev_i16 v18, 15, v18 op_sel_hi:[0,1]
  v_pk_ashrrev_i16 v11, 15, v11 op_sel_hi:[0,1]
  v_pk_ashrrev_i16 v19, 15, v19 op_sel_hi:[0,1]
  v_bfi_b32 v34, v8, 0, v34
  v_bfi_b32 v35, v16, 0, v35
  v_bfi_b32 v38, v9, 0, v38
  v_bfi_b32 v39, v17, 0, v39
  v_bfi_b32 v42, v10, 0, v42
  v_bfi_b32 v43, v18, 0, v43
  v_bfi_b32 v46, v11, 0, v46
  v_bfi_b32 v47, v19, 0, v47
  ds_write_b128 v2, v[32:35] offset:0
  s_add_u32 m0, s37, 94208
  s_add_u32 s56, s50, s49
  buffer_load_dwordx4 v7, s[16:19], s56 offen  lds
  ds_write_b128 v2, v[36:39] offset:64
  s_add_u32 m0, s37, 98304
  s_add_u32 s56, s51, s49
  buffer_load_dwordx4 v7, s[16:19], s56 offen  lds
  ds_write_b128 v2, v[40:43] offset:128
  s_add_u32 m0, s37, 102400
  s_add_u32 s56, s52, s49
  buffer_load_dwordx4 v7, s[16:19], s56 offen  lds
  ds_write_b128 v2, v[44:47] offset:192
  s_add_u32 m0, s37, 106496
  s_add_u32 s56, s53, s49
  buffer_load_dwordx4 v7, s[16:19], s56 offen  lds
  s_setprio 0
  s_add_u32 m0, s37, 110592
  s_add_u32 s56, s54, s49
  buffer_load_dwordx4 v7, s[16:19], s56 offen  lds
  s_add_u32 m0, s37, 114688
  s_add_u32 s56, s55, s49
  buffer_load_dwordx4 v7, s[16:19], s56 offen  lds
  s_waitcnt lgkmcnt(0)
  s_barrier
  s_waitcnt vmcnt(0)
  s_waitcnt lgkmcnt(0)
  s_barrier
  v_subrev_u32 v29, 126976, v3
L_poll6_0_0:
  ds_read_b32 v28, v5 offset:0
  ds_read_b128 v[64:67], v3 offset:0
  s_waitcnt lgkmcnt(0)
  v_cmp_ne_u32 vcc, s3, v28
  s_cbranch_vccnz L_poll6_0_0
  buffer_store_dwordx4 v[64:67], v4, s[24:27], s90 offen sc1
L_poll6_0_1:
  ds_read_b32 v28, v5 offset:4
  ds_read_b128 v[68:71], v3 offset:2048
  s_waitcnt lgkmcnt(0)
  v_cmp_ne_u32 vcc, s3, v28
  s_cbranch_vccnz L_poll6_0_1
  buffer_store_dwordx4 v[68:71], v4, s[24:27], s91 offen sc1
L_poll6_0_2:
  ds_read_b32 v28, v5 offset:8
  ds_read_b128 v[72:75], v3 offset:16640
  s_waitcnt lgkmcnt(0)
  v_cmp_ne_u32 vcc, s3, v28
  s_cbranch_vccnz L_poll6_0_2
  buffer_store_dwordx4 v[72:75], v4, s[24:27], s92 offen sc1
L_poll6_0_3:
  ds_read_b32 v28, v5 offset:12
  ds_read_b128 v[76:79], v3 offset:18688
  s_waitcnt lgkmcnt(0)
  v_cmp_ne_u32 vcc, s3, v28
  s_cbranch_vccnz L_poll6_0_3
  buffer_store_dwordx4 v[76:79], v4, s[24:27], s93 offen sc1
L_poll6_0_4:
  ds_read_b32 v28, v5 offset:16
  ds_read_b128 v[80:83], v29 offset:0
  s_waitcnt lgkmcnt(0)
  v_cmp_ne_u32 vcc, s3, v28
  s_cbranch_vccnz L_poll6_0_4
  buffer_store_dwordx4 v[80:83], v4, s[24:27], s94 offen sc1
L_poll6_0_5:
  ds_read_b32 v28, v5 offset:20
  ds_read_b128 v[84:87], v29 offset:2048
  s_waitcnt lgkmcnt(0)
  v_cmp_ne_u32 vcc, s3, v28
  s_cbranch_vccnz L_poll6_0_5
  buffer_store_dwordx4 v[84:87], v4, s[24:27], s95 offen sc1
  s_endpgm
L_b6:
  s_movk_i32 s57, 640
  s_mov_b32 s58, 0
  s_add_u32 s42, s41, 128
  s_cmp_eq_u32 s42, s57
  s_cselect_b32 s42, s58, s42
  s_add_u32 s43, s42, 128
  s_cmp_eq_u32 s43, s57
  s_cselect_b32 s43, s58, s43
  s_add_u32 s44, s43, 128
  s_cmp_eq_u32 s44, s57
  s_cselect_b32 s44, s58, s44
  s_add_u32 s45, s40, 640
  s_add_u32 s46, s41, 640
  s_add_u32 s47, s42, 640
  s_add_u32 s48, s43, 640
  s_add_u32 s49, s44, 640
  s_mul_i32 s56, s43, 640
  s_add_u32 s81, s56, s59
  s_mul_i32 s56, s45, 640
  s_add_u32 s82, s56, s59
  s_mul_i32 s56, s47, 640
  s_add_u32 s83, s56, s59
  s_mul_i32 s56, s49, 640
  s_add_u32 s84, s56, s59
  s_mov_b32 s38, 0x7fff7fff
  s_mov_b32 s16, s4
  s_and_b32 s17, s5, 0xffff
  s_mov_b32 s18, 10485760
  s_mov_b32 s19, 0x20000
  v_lshrrev_b32 v12, 3, v6
  s_lshl_b32 s56, s39, 3
  v_add_u32 v12, s56, v12
  v_lshrrev_b32 v13, 1, v12
  v_xor_b32 v13, v13, v6
  v_and_b32 v13, 7, v13
  v_mul_u32_u24 v12, 1280, v12
  v_lshl_add_u32 v7, v13, 4, v12
  s_lshl_b32 s37, s39, 10
  s_mul_i32 s50, s36, 40960
  s_add_u32 s50, s50, s34
  s_add_u32 s57, s34, 245760
  s_add_u32 s51, s50, 40960
  s_cmp_eq_u32 s51, s57
  s_cselect_b32 s51, s34, s51
  s_add_u32 s52, s51, 40960
  s_cmp_eq_u32 s52, s57
  s_cselect_b32 s52, s34, s52
  s_add_u32 s53, s52, 40960
  s_cmp_eq_u32 s53, s57
  s_cselect_b32 s53, s34, s53
  s_add_u32 s54, s53, 40960
  s_cmp_eq_u32 s54, s57
  s_cselect_b32 s54, s34, s54
  s_add_u32 s55, s54, 40960
  s_cmp_eq_u32 s55, s57
  s_cselect_b32 s55, s34, s55
  s_add_u32 s90, s50, s59
  s_add_u32 s91, s51, s59
  s_add_u32 s92, s52, s59
  s_add_u32 s93, s53, s59
  s_add_u32 s94, s54, s59
  s_add_u32 s95, s55, s59
  s_mov_b32 s24, s10
  s_and_b32 s25, s11, 0xffff
  s_mov_b32 s26, 10485760
  s_mov_b32 s27, 0x20000
  v_lshrrev_b32 v9, 2, v25
  v_mul_u32_u24 v9, 4160, v9
  v_lshl_add_u32 v14, v24, 8, v9
  v_and_b32 v12, 3, v25
  v_lshl_add_u32 v14, v12, 4, v14
  v_add_u32 v2, 126976, v14
  v_lshrrev_b32 v13, 4, v6
  s_lshl_b32 s56, s39, 3
  s_add_u32 s56, s56, 4
  v_add_u32 v13, s56, v13
  v_lshrrev_b32 v14, 1, v13
  v_xor_b32 v14, v14, v12
  v_and_b32 v14, 3, v14
  v_lshlrev_b32 v14, 4, v14
  v_lshl_add_u32 v14, v13, 6, v14
  v_add_u32 v14, v14, v9
  v_add_u32 v3, 126976, v14
  v_mul_u32_u24 v13, 1280, v13
  v_lshl_add_u32 v4, v25, 4, v13
  v_mov_b32 v5, 160768
  s_mov_b32 s3, 0x01010101
  v_lshl_add_u32 v28, v6, 2, v5
  v_mov_b32 v29, 0
  ds_write_b32 v28, v29
  s_waitcnt vmcnt(0)
  buffer_load_dwordx4 v[48:51], v1, s[20:23], s81 offen offset:0
  v_and_b32 v8, s38, v32
  v_and_b32 v16, s38, v33
  v_and_b32 v9, s38, v36
  v_and_b32 v17, s38, v37
  v_and_b32 v10, s38, v40
  v_and_b32 v18, s38, v41
  v_and_b32 v11, s38, v44
  v_and_b32 v19, s38, v45
  v_pk_max_u16 v12, v8, v9
  v_pk_max_u16 v20, v16, v17
  v_pk_min_u16 v13, v8, v9
  v_pk_min_u16 v21, v16, v17
  v_pk_max_u16 v14, v10, v11
  v_pk_max_u16 v22, v18, v19
  v_pk_min_u16 v15, v10, v11
  v_pk_min_u16 v23, v18, v19
  v_pk_min_u16 v12, v12, v14
  v_pk_min_u16 v20, v20, v22
  v_pk_max_u16 v13, v13, v15
  v_pk_max_u16 v21, v21, v23
  buffer_load_dwordx4 v[52:55], v1, s[20:23], s81 offen offset:1280
  v_pk_max_u16 v12, v12, v13
  v_pk_max_u16 v20, v20, v21
  v_pk_sub_i16 v8, v8, v12
  v_pk_sub_i16 v16, v16, v20
  v_pk_sub_i16 v9, v9, v12
  v_pk_sub_i16 v17, v17, v20
  v_pk_sub_i16 v10, v10, v12
  v_pk_sub_i16 v18, v18, v20
  v_pk_sub_i16 v11, v11, v12
  v_pk_sub_i16 v19, v19, v20
  v_pk_ashrrev_i16 v8, 15, v8 op_sel_hi:[0,1]
  v_pk_ashrrev_i16 v16, 15, v16 op_sel_hi:[0,1]
  v_pk_ashrrev_i16 v9, 15, v9 op_sel_hi:[0,1]
  v_pk_ashrrev_i16 v17, 15, v17 op_sel_hi:[0,1]
  v_pk_ashrrev_i16 v10, 15, v10 op_sel_hi:[0,1]
  v_pk_ashrrev_i16 v18, 15, v18 op_sel_hi:[0,1]
  v_pk_ashrrev_i16 v11, 15, v11 op_sel_hi:[0,1]
  v_pk_ashrrev_i16 v19, 15, v19 op_sel_hi:[0,1]
  v_bfi_b32 v32, v8, 0, v32
  buffer_load_dwordx4 v[56:59], v1, s[20:23], s81 offen offset:2560
  v_bfi_b32 v33, v16, 0, v33
  v_bfi_b32 v36, v9, 0, v36
  v_bfi_b32 v37, v17, 0, v37
  v_bfi_b32 v40, v10, 0, v40
  v_bfi_b32 v41, v18, 0, v41
  v_bfi_b32 v44, v11, 0, v44
  v_bfi_b32 v45, v19, 0, v45
  v_and_b32 v8, s38, v34
  v_and_b32 v16, s38, v35
  v_and_b32 v9, s38, v38
  v_and_b32 v17, s38, v39
  v_and_b32 v10, s38, v42
  v_and_b32 v18, s38, v43
  v_and_b32 v11, s38, v46
  v_and_b32 v19, s38, v47
  v_pk_max_u16 v12, v8, v9
  v_pk_max_u16 v20, v16, v17
  v_pk_min_u16 v13, v8, v9
  v_pk_min_u16 v21, v16, v17
  v_pk_max_u16 v14, v10, v11
  buffer_load_dwordx4 v[60:63], v1, s[20:23], s81 offen offset:3840
  v_pk_max_u16 v22, v18, v19
  v_pk_min_u16 v15, v10, v11
  v_pk_min_u16 v23, v18, v19
  v_pk_min_u16 v12, v12, v14
  v_pk_min_u16 v20, v20, v22
  v_pk_max_u16 v13, v13, v15
  v_pk_max_u16 v21, v21, v23
  v_pk_max_u16 v12, v12, v13
  v_pk_max_u16 v20, v20, v21
  v_pk_sub_i16 v8, v8, v12
  v_pk_sub_i16 v16, v16, v20
  v_pk_sub_i16 v9, v9, v12
  v_pk_sub_i16 v17, v17, v20
  v_pk_sub_i16 v10, v10, v12
  v_pk_sub_i16 v18, v18, v20
  v_pk_sub_i16 v11, v11, v12
  v_pk_sub_i16 v19, v19, v20
  v_pk_ashrrev_i16 v8, 15, v8 op_sel_hi:[0,1]
  v_pk_ashrrev_i16 v16, 15, v16 op_sel_hi:[0,1]
  s_waitcnt lgkmcnt(0)
  s_barrier
  s_setprio 1
  v_pk_ashrrev_i16 v9, 15, v9 op_sel_hi:[0,1]
  v_pk_ashrrev_i16 v17, 15, v17 op_sel_hi:[0,1]
  v_pk_ashrrev_i16 v10, 15, v10 op_sel_hi:[0,1]
  v_pk_ashrrev_i16 v18, 15, v18 op_sel_hi:[0,1]
  v_pk_ashrrev_i16 v11, 15, v11 op_sel_hi:[0,1]
  v_pk_ashrrev_i16 v19, 15, v19 op_sel_hi:[0,1]
  v_bfi_b32 v34, v8, 0, v34
  v_bfi_b32 v35, v16, 0, v35
  v_bfi_b32 v38, v9, 0, v38
  v_bfi_b32 v39, v17, 0, v39
  v_bfi_b32 v42, v10, 0, v42
  v_bfi_b32 v43, v18, 0, v43
  v_bfi_b32 v46, v11, 0, v46
  v_bfi_b32 v47, v19, 0, v47
  ds_write_b128 v2, v[32:35] offset:16640
  s_add_u32 m0, s37, 49152
  s_add_u32 s56, s50, s42
  buffer_load_dwordx4 v7, s[16:19], s56 offen  lds
  ds_write_b128 v2, v[36:39] offset:16704
  s_add_u32 m0, s37, 53248
  s_add_u32 s56, s51, s42
  buffer_load_dwordx4 v7, s[16:19], s56 offen  lds
  ds_write_b128 v2, v[40:43] offset:16768
  s_add_u32 m0, s37, 57344
  s_add_u32 s56, s52, s42
  buffer_load_dwordx4 v7, s[16:19], s56 offen  lds
  ds_write_b128 v2, v[44:47] offset:16832
  s_add_u32 m0, s37, 61440
  s_add_u32 s56, s53, s42
  buffer_load_dwordx4 v7, s[16:19], s56 offen  lds
  s_setprio 0
  s_add_u32 m0, s37, 65536
  s_add_u32 s56, s54, s42
  buffer_load_dwordx4 v7, s[16:19], s56 offen  lds
  s_add_u32 m0, s37, 69632
  s_add_u32 s56, s55, s42
  buffer_load_dwordx4 v7, s[16:19], s56 offen  lds
  s_waitcnt lgkmcnt(0)
  s_barrier
  s_waitcnt vmcnt(6)
  buffer_load_dwordx4 v[32:35], v1, s[20:23], s82 offen offset:0
  v_and_b32 v8, s38, v48
  v_and_b32 v16, s38, v49
  v_and_b32 v9, s38, v52
  v_and_b32 v17, s38, v53
  v_and_b32 v10, s38, v56
  v_and_b32 v18, s38, v57
  v_and_b32 v11, s38, v60
  v_and_b32 v19, s38, v61
  v_pk_max_u16 v12, v8, v9
  v_pk_max_u16 v20, v16, v17
  v_pk_min_u16 v13, v8, v9
  v_pk_min_u16 v21, v16, v17
  v_pk_max_u16 v14, v10, v11
  v_pk_max_u16 v22, v18, v19
  v_pk_min_u16 v15, v10, v11
  v_pk_min_u16 v23, v18, v19
  v_pk_min_u16 v12, v12, v14
  v_pk_min_u16 v20, v20, v22
  v_pk_max_u16 v13, v13, v15
  v_pk_max_u16 v21, v21, v23
  buffer_load_dwordx4 v[36:39], v1, s[20:23], s82 offen offset:1280
  v_pk_max_u16 v12, v12, v13
  v_pk_max_u16 v20, v20, v21
  v_pk_sub_i16 v8, v8, v12
  v_pk_sub_i16 v16, v16, v20
  v_pk_sub_i16 v9, v9, v12
  v_pk_sub_i16 v17, v17, v20
  v_pk_sub_i16 v10, v10, v12
  v_pk_sub_i16 v18, v18, v20
  v_pk_sub_i16 v11, v11, v12
  v_pk_sub_i16 v19, v19, v20
  v_pk_ashrrev_i16 v8, 15, v8 op_sel_hi:[0,1]
  v_pk_ashrrev_i16 v16, 15, v16 op_sel_hi:[0,1]
  v_pk_ashrrev_i16 v9, 15, v9 op_sel_hi:[0,1]
  v_pk_ashrrev_i16 v17, 15, v17 op_sel_hi:[0,1]
  v_pk_ashrrev_i16 v10, 15, v10 op_sel_hi:[0,1]
  v_pk_ashrrev_i16 v18, 15, v18 op_sel_hi:[0,1]
  v_pk_ashrrev_i16 v11, 15, v11 op_sel_hi:[0,1]
  v_pk_ashrrev_i16 v19, 15, v19 op_sel_hi:[0,1]
  v_bfi_b32 v48, v8, 0, v48
  buffer_load_dwordx4 v[40:43], v1, s[20:23], s82 offen offset:2560
  v_bfi_b32 v49, v16, 0, v49
  v_bfi_b32 v52, v9, 0, v52
  v_bfi_b32 v53, v17, 0, v53
  v_bfi_b32 v56, v10, 0, v56
  v_bfi_b32 v57, v18, 0, v57
  v_bfi_b32 v60, v11, 0, v60
  v_bfi_b32 v61, v19, 0, v61
  v_and_b32 v8, s38, v50
  v_and_b32 v16, s38, v51
  v_and_b32 v9, s38, v54
  v_and_b32 v17, s38, v55
  v_and_b32 v10, s38, v58
  v_and_b32 v18, s38, v59
  v_and_b32 v11, s38, v62
  v_and_b32 v19, s38, v63
  v_pk_max_u16 v12, v8, v9
  v_pk_max_u16 v20, v16, v17
  v_pk_min_u16 v13, v8, v9
  v_pk_min_u16 v21, v16, v17
  v_pk_max_u16 v14, v10, v11
  buffer_load_dwordx4 v[44:47], v1, s[20:23], s82 offen offset:3840
  v_pk_max_u16 v22, v18, v19
  v_pk_min_u16 v15, v10, v11
  v_pk_min_u16 v23, v18, v19
  v_pk_min_u16 v12, v12, v14
  v_pk_min_u16 v20, v20, v22
  v_pk_max_u16 v13, v13, v15
  v_pk_max_u16 v21, v21, v23
  v_pk_max_u16 v12, v12, v13
  v_pk_max_u16 v20, v20, v21
  v_pk_sub_i16 v8, v8, v12
  v_pk_sub_i16 v16, v16, v20
  v_pk_sub_i16 v9, v9, v12
  v_pk_sub_i16 v17, v17, v20
  v_pk_sub_i16 v10, v10, v12
  v_pk_sub_i16 v18, v18, v20
  v_pk_sub_i16 v11, v11, v12
  v_pk_sub_i16 v19, v19, v20
  v_pk_ashrrev_i16 v8, 15, v8 op_sel_hi:[0,1]
  v_pk_ashrrev_i16 v16, 15, v16 op_sel_hi:[0,1]
  s_waitcnt vmcnt(4)
  s_waitcnt lgkmcnt(0)
  s_barrier
  s_setprio 1
  v_pk_ashrrev_i16 v9, 15, v9 op_sel_hi:[0,1]
  v_pk_ashrrev_i16 v17, 15, v17 op_sel_hi:[0,1]
  v_pk_ashrrev_i16 v10, 15, v10 op_sel_hi:[0,1]
  v_pk_ashrrev_i16 v18, 15, v18 op_sel_hi:[0,1]
  v_pk_ashrrev_i16 v11, 15, v11 op_sel_hi:[0,1]
  v_pk_ashrrev_i16 v19, 15, v19 op_sel_hi:[0,1]
  v_bfi_b32 v50, v8, 0, v50
  v_bfi_b32 v51, v16, 0, v51
  v_bfi_b32 v54, v9, 0, v54
  v_bfi_b32 v55, v17, 0, v55
  v_bfi_b32 v58, v10, 0, v58
  v_bfi_b32 v59, v18, 0, v59
  v_bfi_b32 v62, v11, 0, v62
  v_bfi_b32 v63, v19, 0, v63
  ds_write_b128 v2, v[48:51] offset:16640
  s_add_u32 m0, s37, 98304
  s_add_u32 s56, s50, s44
  buffer_load_dwordx4 v7, s[16:19], s56 offen  lds
  ds_write_b128 v2, v[52:55] offset:16704
  s_add_u32 m0, s37, 102400
  s_add_u32 s56, s51, s44
  buffer_load_dwordx4 v7, s[16:19], s56 offen  lds
  ds_write_b128 v2, v[56:59] offset:16768
  s_add_u32 m0, s37, 106496
  s_add_u32 s56, s52, s44
  buffer_load_dwordx4 v7, s[16:19], s56 offen  lds
  ds_write_b128 v2, v[60:63] offset:16832
  s_add_u32 m0, s37, 110592
  s_add_u32 s56, s53, s44
  buffer_load_dwordx4 v7, s[16:19], s56 offen  lds
  s_setprio 0
  s_add_u32 m0, s37, 114688
  s_add_u32 s56, s54, s44
  buffer_load_dwordx4 v7, s[16:19], s56 offen  lds
  s_add_u32 m0, s37, 118784
  s_add_u32 s56, s55, s44
  buffer_load_dwordx4 v7, s[16:19], s56 offen  lds
  s_waitcnt lgkmcnt(0)
  s_barrier
  s_waitcnt vmcnt(6)
  buffer_load_dwordx4 v[48:51], v1, s[20:23], s83 offen offset:0
  v_and_b32 v8, s38, v32
  v_and_b32 v16, s38, v33
  v_and_b32 v9, s38, v36
  v_and_b32 v17, s38, v37
  v_and_b32 v10, s38, v40
  v_and_b32 v18, s38, v41
  v_and_b32 v11, s38, v44
  v_and_b32 v19, s38, v45
  v_pk_max_u16 v12, v8, v9
  v_pk_max_u16 v20, v16, v17
  v_pk_min_u16 v13, v8, v9
  v_pk_min_u16 v21, v16, v17
  v_pk_max_u16 v14, v10, v11
  v_pk_max_u16 v22, v18, v19
  v_pk_min_u16 v15, v10, v11
  v_pk_min_u16 v23, v18, v19
  v_pk_min_u16 v12, v12, v14
  v_pk_min_u16 v20, v20, v22
  v_pk_max_u16 v13, v13, v15
  v_pk_max_u16 v21, v21, v23
  buffer_load_dwordx4 v[52:55], v1, s[20:23], s83 offen offset:1280
  v_pk_max_u16 v12, v12, v13
  v_pk_max_u16 v20, v20, v21
  v_pk_sub_i16 v8, v8, v12
  v_pk_sub_i16 v16, v16, v20
  v_pk_sub_i16 v9, v9, v12
  v_pk_sub_i16 v17, v17, v20
  v_pk_sub_i16 v10, v10, v12
  v_pk_sub_i16 v18, v18, v20
  v_pk_sub_i16 v11, v11, v12
  v_pk_sub_i16 v19, v19, v20
  v_pk_ashrrev_i16 v8, 15, v8 op_sel_hi:[0,1]
  v_pk_ashrrev_i16 v16, 15, v16 op_sel_hi:[0,1]
  v_pk_ashrrev_i16 v9, 15, v9 op_sel_hi:[0,1]
  v_pk_ashrrev_i16 v17, 15, v17 op_sel_hi:[0,1]
  v_pk_ashrrev_i16 v10, 15, v10 op_sel_hi:[0,1]
  v_pk_ashrrev_i16 v18, 15, v18 op_sel_hi:[0,1]
  v_pk_ashrrev_i16 v11, 15, v11 op_sel_hi:[0,1]
  v_pk_ashrrev_i16 v19, 15, v19 op_sel_hi:[0,1]
  v_bfi_b32 v32, v8, 0, v32
  buffer_load_dwordx4 v[56:59], v1, s[20:23], s83 offen offset:2560
  v_bfi_b32 v33, v16, 0, v33
  v_bfi_b32 v36, v9, 0, v36
  v_bfi_b32 v37, v17, 0, v37
  v_bfi_b32 v40, v10, 0, v40
  v_bfi_b32 v41, v18, 0, v41
  v_bfi_b32 v44, v11, 0, v44
  v_bfi_b32 v45, v19, 0, v45
  v_and_b32 v8, s38, v34
  v_and_b32 v16, s38, v35
  v_and_b32 v9, s38, v38
  v_and_b32 v17, s38, v39
  v_and_b32 v10, s38, v42
  v_and_b32 v18, s38, v43
  v_and_b32 v11, s38, v46
  v_and_b32 v19, s38, v47
  v_pk_max_u16 v12, v8, v9
  v_pk_max_u16 v20, v16, v17
  v_pk_min_u16 v13, v8, v9
  v_pk_min_u16 v21, v16, v17
  v_pk_max_u16 v14, v10, v11
  buffer_load_dwordx4 v[60:63], v1, s[20:23], s83 offen offset:3840
  v_pk_max_u16 v22, v18, v19
  v_pk_min_u16 v15, v10, v11
  v_pk_min_u16 v23, v18, v19
  v_pk_min_u16 v12, v12, v14
  v_pk_min_u16 v20, v20, v22
  v_pk_max_u16 v13, v13, v15
  v_pk_max_u16 v21, v21, v23
  v_pk_max_u16 v12, v12, v13
  v_pk_max_u16 v20, v20, v21
  v_pk_sub_i16 v8, v8, v12
  v_pk_sub_i16 v16, v16, v20
  v_pk_sub_i16 v9, v9, v12
  v_pk_sub_i16 v17, v17, v20
  v_pk_sub_i16 v10, v10, v12
  v_pk_sub_i16 v18, v18, v20
  v_pk_sub_i16 v11, v11, v12
  v_pk_sub_i16 v19, v19, v20
  v_pk_ashrrev_i16 v8, 15, v8 op_sel_hi:[0,1]
  v_pk_ashrrev_i16 v16, 15, v16 op_sel_hi:[0,1]
  s_waitcnt vmcnt(4)
  s_waitcnt lgkmcnt(0)
  s_barrier
  s_setprio 1
  v_pk_ashrrev_i16 v9, 15, v9 op_sel_hi:[0,1]
  v_pk_ashrrev_i16 v17, 15, v17 op_sel_hi:[0,1]
  v_pk_ashrrev_i16 v10, 15, v10 op_sel_hi:[0,1]
  v_pk_ashrrev_i16 v18, 15, v18 op_sel_hi:[0,1]
  v_pk_ashrrev_i16 v11, 15, v11 op_sel_hi:[0,1]
  v_pk_ashrrev_i16 v19, 15, v19 op_sel_hi:[0,1]
  v_bfi_b32 v34, v8, 0, v34
  v_bfi_b32 v35, v16, 0, v35
  v_bfi_b32 v38, v9, 0, v38
  v_bfi_b32 v39, v17, 0, v39
  v_bfi_b32 v42, v10, 0, v42
  v_bfi_b32 v43, v18, 0, v43
  v_bfi_b32 v46, v11, 0, v46
  v_bfi_b32 v47, v19, 0, v47
  ds_write_b128 v2, v[32:35] offset:16640
  s_add_u32 m0, s37, 20480
  s_add_u32 s56, s50, s46
  buffer_load_dwordx4 v7, s[16:19], s56 offen  lds
  ds_write_b128 v2, v[36:39] offset:16704
  s_add_u32 m0, s37, 24576
  s_add_u32 s56, s51, s46
  buffer_load_dwordx4 v7, s[16:19], s56 offen  lds
  ds_write_b128 v2, v[40:43] offset:16768
  s_add_u32 m0, s37, 28672
  s_add_u32 s56, s52, s46
  buffer_load_dwordx4 v7, s[16:19], s56 offen  lds
  ds_write_b128 v2, v[44:47] offset:16832
  s_add_u32 m0, s37, 32768
  s_add_u32 s56, s53, s46
  buffer_load_dwordx4 v7, s[16:19], s56 offen  lds
  s_setprio 0
  s_add_u32 m0, s37, 36864
  s_add_u32 s56, s54, s46
  buffer_load_dwordx4 v7, s[16:19], s56 offen  lds
  s_add_u32 m0, s37, 40960
  s_add_u32 s56, s55, s46
  buffer_load_dwordx4 v7, s[16:19], s56 offen  lds
  s_waitcnt lgkmcnt(0)
  s_barrier
  s_waitcnt vmcnt(6)
  buffer_load_dwordx4 v[32:35], v1, s[20:23], s84 offen offset:0
  v_and_b32 v8, s38, v48
  v_and_b32 v16, s38, v49
  v_and_b32 v9, s38, v52
  v_and_b32 v17, s38, v53
  v_and_b32 v10, s38, v56
  v_and_b32 v18, s38, v57
  v_and_b32 v11, s38, v60
  v_and_b32 v19, s38, v61
  v_pk_max_u16 v12, v8, v9
  v_pk_max_u16 v20, v16, v17
  v_pk_min_u16 v13, v8, v9
  v_pk_min_u16 v21, v16, v17
  v_pk_max_u16 v14, v10, v11
  v_pk_max_u16 v22, v18, v19
  v_pk_min_u16 v15, v10, v11
  v_pk_min_u16 v23, v18, v19
  v_pk_min_u16 v12, v12, v14
  v_pk_min_u16 v20, v20, v22
  v_pk_max_u16 v13, v13, v15
  v_pk_max_u16 v21, v21, v23
  buffer_load_dwordx4 v[36:39], v1, s[20:23], s84 offen offset:1280
  v_pk_max_u16 v12, v12, v13
  v_pk_max_u16 v20, v20, v21
  v_pk_sub_i16 v8, v8, v12
  v_pk_sub_i16 v16, v16, v20
  v_pk_sub_i16 v9, v9, v12
  v_pk_sub_i16 v17, v17, v20
  v_pk_sub_i16 v10, v10, v12
  v_pk_sub_i16 v18, v18, v20
  v_pk_sub_i16 v11, v11, v12
  v_pk_sub_i16 v19, v19, v20
  v_pk_ashrrev_i16 v8, 15, v8 op_sel_hi:[0,1]
  v_pk_ashrrev_i16 v16, 15, v16 op_sel_hi:[0,1]
  v_pk_ashrrev_i16 v9, 15, v9 op_sel_hi:[0,1]
  v_pk_ashrrev_i16 v17, 15, v17 op_sel_hi:[0,1]
  v_pk_ashrrev_i16 v10, 15, v10 op_sel_hi:[0,1]
  v_pk_ashrrev_i16 v18, 15, v18 op_sel_hi:[0,1]
  v_pk_ashrrev_i16 v11, 15, v11 op_sel_hi:[0,1]
  v_pk_ashrrev_i16 v19, 15, v19 op_sel_hi:[0,1]
  v_bfi_b32 v48, v8, 0, v48
  buffer_load_dwordx4 v[40:43], v1, s[20:23], s84 offen offset:2560
  v_bfi_b32 v49, v16, 0, v49
  v_bfi_b32 v52, v9, 0, v52
  v_bfi_b32 v53, v17, 0, v53
  v_bfi_b32 v56, v10, 0, v56
  v_bfi_b32 v57, v18, 0, v57
  v_bfi_b32 v60, v11, 0, v60
  v_bfi_b32 v61, v19, 0, v61
  v_and_b32 v8, s38, v50
  v_and_b32 v16, s38, v51
  v_and_b32 v9, s38, v54
  v_and_b32 v17, s38, v55
  v_and_b32 v10, s38, v58
  v_and_b32 v18, s38, v59
  v_and_b32 v11, s38, v62
  v_and_b32 v19, s38, v63
  v_pk_max_u16 v12, v8, v9
  v_pk_max_u16 v20, v16, v17
  v_pk_min_u16 v13, v8, v9
  v_pk_min_u16 v21, v16, v17
  v_pk_max_u16 v14, v10, v11
  buffer_load_dwordx4 v[44:47], v1, s[20:23], s84 offen offset:3840
  v_pk_max_u16 v22, v18, v19
  v_pk_min_u16 v15, v10, v11
  v_pk_min_u16 v23, v18, v19
  v_pk_min_u16 v12, v12, v14
  v_pk_min_u16 v20, v20, v22
  v_pk_max_u16 v13, v13, v15
  v_pk_max_u16 v21, v21, v23
  v_pk_max_u16 v12, v12, v13
  v_pk_max_u16 v20, v20, v21
  v_pk_sub_i16 v8, v8, v12
  v_pk_sub_i16 v16, v16, v20
  v_pk_sub_i16 v9, v9, v12
  v_pk_sub_i16 v17, v17, v20
  v_pk_sub_i16 v10, v10, v12
  v_pk_sub_i16 v18, v18, v20
  v_pk_sub_i16 v11, v11, v12
  v_pk_sub_i16 v19, v19, v20
  v_pk_ashrrev_i16 v8, 15, v8 op_sel_hi:[0,1]
  v_pk_ashrrev_i16 v16, 15, v16 op_sel_hi:[0,1]
  s_waitcnt vmcnt(4)
  s_waitcnt lgkmcnt(0)
  s_barrier
  s_setprio 1
  v_pk_ashrrev_i16 v9, 15, v9 op_sel_hi:[0,1]
  v_pk_ashrrev_i16 v17, 15, v17 op_sel_hi:[0,1]
  v_pk_ashrrev_i16 v10, 15, v10 op_sel_hi:[0,1]
  v_pk_ashrrev_i16 v18, 15, v18 op_sel_hi:[0,1]
  v_pk_ashrrev_i16 v11, 15, v11 op_sel_hi:[0,1]
  v_pk_ashrrev_i16 v19, 15, v19 op_sel_hi:[0,1]
  v_bfi_b32 v50, v8, 0, v50
  v_bfi_b32 v51, v16, 0, v51
  v_bfi_b32 v54, v9, 0, v54
  v_bfi_b32 v55, v17, 0, v55
  v_bfi_b32 v58, v10, 0, v58
  v_bfi_b32 v59, v18, 0, v59
  v_bfi_b32 v62, v11, 0, v62
  v_bfi_b32 v63, v19, 0, v63
  ds_write_b128 v2, v[48:51] offset:16640
  s_add_u32 m0, s37, 69632
  s_add_u32 s56, s50, s48
  buffer_load_dwordx4 v7, s[16:19], s56 offen  lds
  ds_write_b128 v2, v[52:55] offset:16704
  s_add_u32 m0, s37, 73728
  s_add_u32 s56, s51, s48
  buffer_load_dwordx4 v7, s[16:19], s56 offen  lds
  ds_write_b128 v2, v[56:59] offset:16768
  s_add_u32 m0, s37, 77824
  s_add_u32 s56, s52, s48
  buffer_load_dwordx4 v7, s[16:19], s56 offen  lds
  ds_write_b128 v2, v[60:63] offset:16832
  s_add_u32 m0, s37, 81920
  s_add_u32 s56, s53, s48
  buffer_load_dwordx4 v7, s[16:19], s56 offen  lds
  s_setprio 0
  s_add_u32 m0, s37, 86016
  s_add_u32 s56, s54, s48
  buffer_load_dwordx4 v7, s[16:19], s56 offen  lds
  s_add_u32 m0, s37, 90112
  s_add_u32 s56, s55, s48
  buffer_load_dwordx4 v7, s[16:19], s56 offen  lds
  s_waitcnt lgkmcnt(0)
  s_barrier
  s_waitcnt vmcnt(6)
  v_and_b32 v8, s38, v32
  v_and_b32 v16, s38, v33
  v_and_b32 v9, s38, v36
  v_and_b32 v17, s38, v37
  v_and_b32 v10, s38, v40
  v_and_b32 v18, s38, v41
  v_and_b32 v11, s38, v44
  v_and_b32 v19, s38, v45
  v_pk_max_u16 v12, v8, v9
  v_pk_max_u16 v20, v16, v17
  v_pk_min_u16 v13, v8, v9
  v_pk_min_u16 v21, v16, v17
  v_pk_max_u16 v14, v10, v11
  v_pk_max_u16 v22, v18, v19
  v_pk_min_u16 v15, v10, v11
  v_pk_min_u16 v23, v18, v19
  v_pk_min_u16 v12, v12, v14
  v_pk_min_u16 v20, v20, v22
  v_pk_max_u16 v13, v13, v15
  v_pk_max_u16 v21, v21, v23
  v_pk_max_u16 v12, v12, v13
  v_pk_max_u16 v20, v20, v21
  v_pk_sub_i16 v8, v8, v12
  v_pk_sub_i16 v16, v16, v20
  v_pk_sub_i16 v9, v9, v12
  v_pk_sub_i16 v17, v17, v20
  v_pk_sub_i16 v10, v10, v12
  v_pk_sub_i16 v18, v18, v20
  v_pk_sub_i16 v11, v11, v12
  v_pk_sub_i16 v19, v19, v20
  v_pk_ashrrev_i16 v8, 15, v8 op_sel_hi:[0,1]
  v_pk_ashrrev_i16 v16, 15, v16 op_sel_hi:[0,1]
  v_pk_ashrrev_i16 v9, 15, v9 op_sel_hi:[0,1]
  v_pk_ashrrev_i16 v17, 15, v17 op_sel_hi:[0,1]
  v_pk_ashrrev_i16 v10, 15, v10 op_sel_hi:[0,1]
  v_pk_ashrrev_i16 v18, 15, v18 op_sel_hi:[0,1]
  v_pk_ashrrev_i16 v11, 15, v11 op_sel_hi:[0,1]
  v_pk_ashrrev_i16 v19, 15, v19 op_sel_hi:[0,1]
  v_bfi_b32 v32, v8, 0, v32
  v_bfi_b32 v33, v16, 0, v33
  v_bfi_b32 v36, v9, 0, v36
  v_bfi_b32 v37, v17, 0, v37
  v_bfi_b32 v40, v10, 0, v40
  v_bfi_b32 v41, v18, 0, v41
  v_bfi_b32 v44, v11, 0, v44
  v_bfi_b32 v45, v19, 0, v45
  v_and_b32 v8, s38, v34
  v_and_b32 v16, s38, v35
  v_and_b32 v9, s38, v38
  v_and_b32 v17, s38, v39
  v_and_b32 v10, s38, v42
  v_and_b32 v18, s38, v43
  v_and_b32 v11, s38, v46
  v_and_b32 v19, s38, v47
  v_pk_max_u16 v12, v8, v9
  v_pk_max_u16 v20, v16, v17
  v_pk_min_u16 v13, v8, v9
  v_pk_min_u16 v21, v16, v17
  v_pk_max_u16 v14, v10, v11
  v_pk_max_u16 v22, v18, v19
  v_pk_min_u16 v15, v10, v11
  v_pk_min_u16 v23, v18, v19
  v_pk_min_u16 v12, v12, v14
  v_pk_min_u16 v20, v20, v22
  v_pk_max_u16 v13, v13, v15
  v_pk_max_u16 v21, v21, v23
  v_pk_max_u16 v12, v12, v13
  v_pk_max_u16 v20, v20, v21
  v_pk_sub_i16 v8, v8, v12
  v_pk_sub_i16 v16, v16, v20
  v_pk_sub_i16 v9, v9, v12
  v_pk_sub_i16 v17, v17, v20
  v_pk_sub_i16 v10, v10, v12
  v_pk_sub_i16 v18, v18, v20
  v_pk_sub_i16 v11, v11, v12
  v_pk_sub_i16 v19, v19, v20
  v_pk_ashrrev_i16 v8, 15, v8 op_sel_hi:[0,1]
  v_pk_ashrrev_i16 v16, 15, v16 op_sel_hi:[0,1]
  s_waitcnt vmcnt(0)
  s_waitcnt lgkmcnt(0)
  s_barrier
  s_setprio 1
  v_pk_ashrrev_i16 v9, 15, v9 op_sel_hi:[0,1]
  v_pk_ashrrev_i16 v17, 15, v17 op_sel_hi:[0,1]
  v_pk_ashrrev_i16 v10, 15, v10 op_sel_hi:[0,1]
  v_pk_ashrrev_i16 v18, 15, v18 op_sel_hi:[0,1]
  v_pk_ashrrev_i16 v11, 15, v11 op_sel_hi:[0,1]
  v_pk_ashrrev_i16 v19, 15, v19 op_sel_hi:[0,1]
  v_bfi_b32 v34, v8, 0, v34
  v_bfi_b32 v35, v16, 0, v35
  v_bfi_b32 v38, v9, 0, v38
  v_bfi_b32 v39, v17, 0, v39
  v_bfi_b32 v42, v10, 0, v42
  v_bfi_b32 v43, v18, 0, v43
  v_bfi_b32 v46, v11, 0, v46
  v_bfi_b32 v47, v19, 0, v47
  ds_write_b128 v2, v[32:35] offset:16640
  ds_write_b128 v2, v[36:39] offset:16704
  ds_write_b128 v2, v[40:43] offset:16768
  ds_write_b128 v2, v[44:47] offset:16832
  s_setprio 0
  s_waitcnt lgkmcnt(0)
  s_barrier
  v_subrev_u32 v29, 126976, v3
L_poll6_1_0:
  ds_read_b32 v28, v5 offset:0
  ds_read_b128 v[64:67], v3 offset:0
  s_waitcnt lgkmcnt(0)
  v_cmp_ne_u32 vcc, s3, v28
  s_cbranch_vccnz L_poll6_1_0
  buffer_store_dwordx4 v[64:67], v4, s[24:27], s90 offen sc1
L_poll6_1_1:
  ds_read_b32 v28, v5 offset:4
  ds_read_b128 v[68:71], v3 offset:2048
  s_waitcnt lgkmcnt(0)
  v_cmp_ne_u32 vcc, s3, v28
  s_cbranch_vccnz L_poll6_1_1
  buffer_store_dwordx4 v[68:71], v4, s[24:27], s91 offen sc1
L_poll6_1_2:
  ds_read_b32 v28, v5 offset:8
  ds_read_b128 v[72:75], v3 offset:16640
  s_waitcnt lgkmcnt(0)
  v_cmp_ne_u32 vcc, s3, v28
  s_cbranch_vccnz L_poll6_1_2
  buffer_store_dwordx4 v[72:75], v4, s[24:27], s92 offen sc1
L_poll6_1_3:
  ds_read_b32 v28, v5 offset:12
  ds_read_b128 v[76:79], v3 offset:18688
  s_waitcnt lgkmcnt(0)
  v_cmp_ne_u32 vcc, s3, v28
  s_cbranch_vccnz L_poll6_1_3
  buffer_store_dwordx4 v[76:79], v4, s[24:27], s93 offen sc1
L_poll6_1_4:
  ds_read_b32 v28, v5 offset:16
  ds_read_b128 v[80:83], v29 offset:0
  s_waitcnt lgkmcnt(0)
  v_cmp_ne_u32 vcc, s3, v28
  s_cbranch_vccnz L_poll6_1_4
  buffer_store_dwordx4 v[80:83], v4, s[24:27], s94 offen sc1
L_poll6_1_5:
  ds_read_b32 v28, v5 offset:20
  ds_read_b128 v[84:87], v29 offset:2048
  s_waitcnt lgkmcnt(0)
  v_cmp_ne_u32 vcc, s3, v28
  s_cbranch_vccnz L_poll6_1_5
  buffer_store_dwordx4 v[84:87], v4, s[24:27], s95 offen sc1
  s_endpgm
L_c6:
  s_movk_i32 s57, 640
  s_mov_b32 s58, 0
  v_and_b32 v2, 31, v1
  v_lshrrev_b32 v3, 5, v1
  v_lshrrev_b32 v4, 1, v2
  v_and_b32 v4, 7, v4
  v_xor_b32 v4, v4, v3
  v_lshlrev_b32 v4, 4, v4
  v_lshl_add_u32 v148, v2, 7, v4
  v_xor_b32 v149, 32, v148
  v_xor_b32 v150, 64, v148
  v_xor_b32 v151, 96, v148
  v_lshlrev_b32 v4, 9, v3
  v_bfe_u32 v5, v1, 4, 1
  v_lshl_add_u32 v4, v5, 5, v4
  v_bfe_u32 v5, v1, 2, 2
  v_lshl_add_u32 v4, v5, 6, v4
  v_and_b32 v5, 3, v1
  v_lshl_add_u32 v4, v5, 3, v4
  s_mul_i32 s56, s32, 4160
  s_add_u32 s56, s56, 126976
  v_add_u32 v152, s56, v4
  v_bfe_u32 v5, v1, 1, 2
  v_xor_b32 v5, v5, v3
  v_lshlrev_b32 v5, 4, v5
  v_lshl_add_u32 v5, v2, 6, v5
  v_add_u32 v154, s56, v5
  s_lshl_b32 s56, s32, 7
  s_add_u32 s56, s56, 160256
  v_lshlrev_b32 v4, 4, v3
  v_add_u32 v155, s56, v4
  s_setprio 3
  s_waitcnt vmcnt(6)
  s_barrier
  ds_read_b64_tr_b16 v[96:97], v152 offset:0
  ds_read_b64_tr_b16 v[98:99], v152 offset:256
  ds_read_b128 v[80:83], v155 offset:0
  ds_read_b128 v[84:87], v155 offset:32
  ds_read_b128 v[88:91], v155 offset:64
  ds_read_b128 v[92:95], v155 offset:96
  ds_read_b128 v[128:131], v148 offset:0
  ds_read_b64_tr_b16 v[100:101], v152 offset:1024
  ds_read_b64_tr_b16 v[102:103], v152 offset:1280
  ds_read_b128 v[132:135], v149 offset:0
  ds_read_b64_tr_b16 v[104:105], v152 offset:2048
  ds_read_b64_tr_b16 v[106:107], v152 offset:2304
  ds_read_b128 v[136:139], v150 offset:0
  ds_read_b64_tr_b16 v[108:109], v152 offset:3072
  ds_read_b64_tr_b16 v[110:111], v152 offset:3328
  s_waitcnt lgkmcnt(13)
  ds_read_b128 v[140:143], v151 offset:0
  ds_read_b128 v[144:147], v148 offset:4096
  s_waitcnt lgkmcnt(10)
  v_mfma_f32_32x32x16_bf16 v[0:15], v[96:99], v[128:131], v[80:95]
  ds_read_b128 v[128:131], v149 offset:4096
  s_waitcnt lgkmcnt(8)
  v_mfma_f32_32x32x16_bf16 v[0:15], v[100:103], v[132:135], v[0:15]
  ds_read_b128 v[132:135], v150 offset:4096
  s_waitcnt lgkmcnt(6)
  v_mfma_f32_32x32x16_bf16 v[0:15], v[104:107], v[136:139], v[0:15]
  ds_read_b128 v[136:139], v151 offset:4096
  s_waitcnt lgkmcnt(4)
  v_mfma_f32_32x32x16_bf16 v[0:15], v[108:111], v[140:143], v[0:15]
  ds_read_b128 v[140:143], v148 offset:8192
  s_waitcnt lgkmcnt(4)
  v_mfma_f32_32x32x16_bf16 v[16:31], v[96:99], v[144:147], v[80:95]
  ds_read_b128 v[144:147], v149 offset:8192
  s_waitcnt lgkmcnt(4)
  v_mfma_f32_32x32x16_bf16 v[16:31], v[100:103], v[128:131], v[16:31]
  ds_read_b128 v[128:131], v150 offset:8192
  s_waitcnt lgkmcnt(4)
  v_mfma_f32_32x32x16_bf16 v[16:31], v[104:107], v[132:135], v[16:31]
  ds_read_b128 v[132:135], v151 offset:8192
  s_waitcnt lgkmcnt(4)
  v_mfma_f32_32x32x16_bf16 v[16:31], v[108:111], v[136:139], v[16:31]
  ds_read_b128 v[136:139], v148 offset:12288
  s_add_u32 s56, s32, 160768
  v_mov_b32 v153, s56
  v_mov_b32 v155, 1
  s_waitcnt lgkmcnt(4)
  v_mfma_f32_32x32x16_bf16 v[32:47], v[96:99], v[140:143], v[80:95]
  ds_read_b128 v[140:143], v149 offset:12288
  s_waitcnt lgkmcnt(4)
  v_mfma_f32_32x32x16_bf16 v[32:47], v[100:103], v[144:147], v[32:47]
  ds_read_b128 v[144:147], v150 offset:12288
  s_waitcnt lgkmcnt(4)
  v_mfma_f32_32x32x16_bf16 v[32:47], v[104:107], v[128:131], v[32:47]
  ds_read_b128 v[128:131], v151 offset:12288
  s_waitcnt lgkmcnt(4)
  v_mfma_f32_32x32x16_bf16 v[32:47], v[108:111], v[132:135], v[32:47]
  ds_read_b128 v[132:135], v148 offset:16384
  s_waitcnt lgkmcnt(4)
  v_mfma_f32_32x32x16_bf16 v[48:63], v[96:99], v[136:139], v[80:95]
  ds_read_b128 v[136:139], v149 offset:16384
  s_waitcnt lgkmcnt(4)
  v_mfma_f32_32x32x16_bf16 v[48:63], v[100:103], v[140:143], v[48:63]
  ds_read_b128 v[140:143], v150 offset:16384
  s_waitcnt lgkmcnt(4)
  v_mfma_f32_32x32x16_bf16 v[48:63], v[104:107], v[144:147], v[48:63]
  ds_read_b128 v[144:147], v151 offset:16384
  s_waitcnt lgkmcnt(4)
  v_mfma_f32_32x32x16_bf16 v[48:63], v[108:111], v[128:131], v[48:63]
  ds_read_b128 v[128:131], v148 offset:20480
  s_waitcnt lgkmcnt(4)
  v_mfma_f32_32x32x16_bf16 v[64:79], v[96:99], v[132:135], v[80:95]
  ds_read_b128 v[132:135], v149 offset:20480
  s_waitcnt lgkmcnt(4)
  v_mfma_f32_32x32x16_bf16 v[64:79], v[100:103], v[136:139], v[64:79]
  ds_read_b128 v[136:139], v150 offset:20480
  s_waitcnt lgkmcnt(4)
  v_mfma_f32_32x32x16_bf16 v[64:79], v[104:107], v[140:143], v[64:79]
  ds_read_b128 v[140:143], v151 offset:20480
  s_waitcnt lgkmcnt(4)
  v_mfma_f32_32x32x16_bf16 v[64:79], v[108:111], v[144:147], v[64:79]
  s_waitcnt vmcnt(0)
  s_barrier
  ds_read_b128 v[144:147], v148 offset:24576
  ds_read_b64_tr_b16 v[112:113], v152 offset:16640
  ds_read_b64_tr_b16 v[114:115], v152 offset:16896
  s_waitcnt lgkmcnt(6)
  v_mfma_f32_32x32x16_bf16 v[80:95], v[96:99], v[128:131], v[80:95]
  ds_read_b128 v[128:131], v149 offset:24576
  ds_read_b64_tr_b16 v[116:117], v152 offset:17664
  ds_read_b64_tr_b16 v[118:119], v152 offset:17920
  s_waitcnt lgkmcnt(8)
  v_mfma_f32_32x32x16_bf16 v[80:95], v[100:103], v[132:135], v[80:95]
  ds_read_b128 v[132:135], v150 offset:24576
  ds_read_b64_tr_b16 v[120:121], v152 offset:18688
  ds_read_b64_tr_b16 v[122:123], v152 offset:18944
  s_waitcnt lgkmcnt(10)
  v_mfma_f32_32x32x16_bf16 v[80:95], v[104:107], v[136:139], v[80:95]
  ds_read_b128 v[136:139], v151 offset:24576
  ds_read_b64_tr_b16 v[124:125], v152 offset:19712
  ds_read_b64_tr_b16 v[126:127], v152 offset:19968
  s_waitcnt lgkmcnt(12)
  v_mfma_f32_32x32x16_bf16 v[80:95], v[108:111], v[140:143], v[80:95]
  ds_read_b128 v[140:143], v148 offset:28672
  s_waitcnt lgkmcnt(10)
  v_mfma_f32_32x32x16_bf16 v[0:15], v[112:115], v[144:147], v[0:15]
  ds_read_b128 v[144:147], v149 offset:28672
  s_waitcnt lgkmcnt(8)
  v_mfma_f32_32x32x16_bf16 v[0:15], v[116:119], v[128:131], v[0:15]
  ds_read_b128 v[128:131], v150 offset:28672
  s_waitcnt lgkmcnt(6)
  v_mfma_f32_32x32x16_bf16 v[0:15], v[120:123], v[132:135], v[0:15]
  ds_read_b128 v[132:135], v151 offset:28672
  s_waitcnt lgkmcnt(4)
  v_mfma_f32_32x32x16_bf16 v[0:15], v[124:127], v[136:139], v[0:15]
  ds_read_b128 v[136:139], v148 offset:32768
  s_waitcnt lgkmcnt(4)
  v_mfma_f32_32x32x16_bf16 v[16:31], v[112:115], v[140:143], v[16:31]
  ds_read_b128 v[140:143], v149 offset:32768
  s_waitcnt lgkmcnt(4)
  v_mfma_f32_32x32x16_bf16 v[16:31], v[116:119], v[144:147], v[16:31]
  ds_read_b128 v[144:147], v150 offset:32768
  s_waitcnt lgkmcnt(4)
  v_mfma_f32_32x32x16_bf16 v[16:31], v[120:123], v[128:131], v[16:31]
  ds_read_b128 v[128:131], v151 offset:32768
  s_waitcnt lgkmcnt(4)
  v_mfma_f32_32x32x16_bf16 v[16:31], v[124:127], v[132:135], v[16:31]
  ds_read_b128 v[132:135], v148 offset:36864
  s_waitcnt lgkmcnt(4)
  v_mfma_f32_32x32x16_bf16 v[32:47], v[112:115], v[136:139], v[32:47]
  ds_read_b128 v[136:139], v149 offset:36864
  s_waitcnt lgkmcnt(4)
  v_mfma_f32_32x32x16_bf16 v[32:47], v[116:119], v[140:143], v[32:47]
  ds_read_b128 v[140:143], v150 offset:36864
  s_waitcnt lgkmcnt(4)
  v_mfma_f32_32x32x16_bf16 v[32:47], v[120:123], v[144:147], v[32:47]
  ds_read_b128 v[144:147], v151 offset:36864
  s_waitcnt lgkmcnt(4)
  v_mfma_f32_32x32x16_bf16 v[32:47], v[124:127], v[128:131], v[32:47]
  ds_read_b128 v[128:131], v148 offset:40960
  s_waitcnt lgkmcnt(4)
  v_mfma_f32_32x32x16_bf16 v[48:63], v[112:115], v[132:135], v[48:63]
  ds_read_b128 v[132:135], v149 offset:40960
  s_waitcnt lgkmcnt(4)
  v_mfma_f32_32x32x16_bf16 v[48:63], v[116:119], v[136:139], v[48:63]
  ds_read_b128 v[136:139], v150 offset:40960
  s_waitcnt lgkmcnt(4)
  v_mfma_f32_32x32x16_bf16 v[48:63], v[120:123], v[140:143], v[48:63]
  ds_read_b128 v[140:143], v151 offset:40960
  s_waitcnt lgkmcnt(4)
  v_mfma_f32_32x32x16_bf16 v[48:63], v[124:127], v[144:147], v[48:63]
  ds_read_b128 v[144:147], v148 offset:45056
  s_waitcnt lgkmcnt(4)
  v_mfma_f32_32x32x16_bf16 v[64:79], v[112:115], v[128:131], v[64:79]
  ds_read_b128 v[128:131], v149 offset:45056
  s_waitcnt lgkmcnt(4)
  v_mfma_f32_32x32x16_bf16 v[64:79], v[116:119], v[132:135], v[64:79]
  ds_read_b128 v[132:135], v150 offset:45056
  s_waitcnt lgkmcnt(4)
  v_mfma_f32_32x32x16_bf16 v[64:79], v[120:123], v[136:139], v[64:79]
  ds_read_b128 v[136:139], v151 offset:45056
  s_waitcnt lgkmcnt(4)
  v_mfma_f32_32x32x16_bf16 v[64:79], v[124:127], v[140:143], v[64:79]
  s_barrier
  ds_read_b128 v[140:143], v148 offset:49152
  ds_read_b64_tr_b16 v[96:97], v152 offset:0
  ds_read_b64_tr_b16 v[98:99], v152 offset:256
  s_waitcnt lgkmcnt(6)
  v_mfma_f32_32x32x16_bf16 v[80:95], v[112:115], v[144:147], v[80:95]
  ds_read_b128 v[144:147], v149 offset:49152
  ds_read_b64_tr_b16 v[100:101], v152 offset:1024
  ds_read_b64_tr_b16 v[102:103], v152 offset:1280
  s_waitcnt lgkmcnt(8)
  v_mfma_f32_32x32x16_bf16 v[80:95], v[116:119], v[128:131], v[80:95]
  ds_read_b128 v[128:131], v150 offset:49152
  ds_read_b64_tr_b16 v[104:105], v152 offset:2048
  ds_read_b64_tr_b16 v[106:107], v152 offset:2304
  s_waitcnt lgkmcnt(10)
  v_mfma_f32_32x32x16_bf16 v[80:95], v[120:123], v[132:135], v[80:95]
  ds_read_b128 v[132:135], v151 offset:49152
  ds_read_b64_tr_b16 v[108:109], v152 offset:3072
  ds_read_b64_tr_b16 v[110:111], v152 offset:3328
  s_waitcnt lgkmcnt(12)
  v_mfma_f32_32x32x16_bf16 v[80:95], v[124:127], v[136:139], v[80:95]
  ds_read_b128 v[136:139], v148 offset:53248
  s_waitcnt lgkmcnt(10)
  v_mfma_f32_32x32x16_bf16 v[0:15], v[96:99], v[140:143], v[0:15]
  ds_read_b128 v[140:143], v149 offset:53248
  s_waitcnt lgkmcnt(8)
  v_mfma_f32_32x32x16_bf16 v[0:15], v[100:103], v[144:147], v[0:15]
  ds_read_b128 v[144:147], v150 offset:53248
  s_waitcnt lgkmcnt(6)
  v_mfma_f32_32x32x16_bf16 v[0:15], v[104:107], v[128:131], v[0:15]
  ds_read_b128 v[128:131], v151 offset:53248
  s_waitcnt lgkmcnt(4)
  v_mfma_f32_32x32x16_bf16 v[0:15], v[108:111], v[132:135], v[0:15]
  ds_read_b128 v[132:135], v148 offset:57344
  s_waitcnt lgkmcnt(4)
  v_mfma_f32_32x32x16_bf16 v[16:31], v[96:99], v[136:139], v[16:31]
  ds_read_b128 v[136:139], v149 offset:57344
  s_waitcnt lgkmcnt(4)
  v_mfma_f32_32x32x16_bf16 v[16:31], v[100:103], v[140:143], v[16:31]
  ds_read_b128 v[140:143], v150 offset:57344
  s_waitcnt lgkmcnt(4)
  v_mfma_f32_32x32x16_bf16 v[16:31], v[104:107], v[144:147], v[16:31]
  ds_read_b128 v[144:147], v151 offset:57344
  s_waitcnt lgkmcnt(4)
  v_mfma_f32_32x32x16_bf16 v[16:31], v[108:111], v[128:131], v[16:31]
  ds_read_b128 v[128:131], v148 offset:61440
  s_waitcnt lgkmcnt(4)
  v_mfma_f32_32x32x16_bf16 v[32:47], v[96:99], v[132:135], v[32:47]
  ds_read_b128 v[132:135], v149 offset:61440
  s_waitcnt lgkmcnt(4)
  v_mfma_f32_32x32x16_bf16 v[32:47], v[100:103], v[136:139], v[32:47]
  ds_read_b128 v[136:139], v150 offset:61440
  s_waitcnt lgkmcnt(4)
  v_mfma_f32_32x32x16_bf16 v[32:47], v[104:107], v[140:143], v[32:47]
  ds_read_b128 v[140:143], v151 offset:61440
  s_waitcnt lgkmcnt(4)
  v_mfma_f32_32x32x16_bf16 v[32:47], v[108:111], v[144:147], v[32:47]
  v_xor_b32 v148, 0x10000, v148
  ds_read_b128 v[144:147], v148 offset:0
  s_waitcnt lgkmcnt(4)
  v_mfma_f32_32x32x16_bf16 v[48:63], v[96:99], v[128:131], v[48:63]
  v_xor_b32 v149, 0x10000, v149
  ds_read_b128 v[128:131], v149 offset:0
  s_waitcnt lgkmcnt(4)
  v_mfma_f32_32x32x16_bf16 v[48:63], v[100:103], v[132:135], v[48:63]
  v_xor_b32 v150, 0x10000, v150
  ds_read_b128 v[132:135], v150 offset:0
  s_waitcnt lgkmcnt(4)
  v_mfma_f32_32x32x16_bf16 v[48:63], v[104:107], v[136:139], v[48:63]
  v_xor_b32 v151, 0x10000, v151
  ds_read_b128 v[136:139], v151 offset:0
  s_waitcnt lgkmcnt(4)
  v_mfma_f32_32x32x16_bf16 v[48:63], v[108:111], v[140:143], v[48:63]
  ds_read_b128 v[140:143], v148 offset:4096
  s_waitcnt lgkmcnt(4)
  v_mfma_f32_32x32x16_bf16 v[64:79], v[96:99], v[144:147], v[64:79]
  ds_read_b128 v[144:147], v149 offset:4096
  s_waitcnt lgkmcnt(4)
  v_mfma_f32_32x32x16_bf16 v[64:79], v[100:103], v[128:131], v[64:79]
  ds_read_b128 v[128:131], v150 offset:4096
  s_waitcnt lgkmcnt(4)
  v_mfma_f32_32x32x16_bf16 v[64:79], v[104:107], v[132:135], v[64:79]
  ds_read_b128 v[132:135], v151 offset:4096
  s_waitcnt lgkmcnt(4)
  v_mfma_f32_32x32x16_bf16 v[64:79], v[108:111], v[136:139], v[64:79]
  s_barrier
  ds_read_b128 v[136:139], v148 offset:8192
  ds_read_b64_tr_b16 v[112:113], v152 offset:16640
  ds_read_b64_tr_b16 v[114:115], v152 offset:16896
  s_waitcnt lgkmcnt(6)
  v_mfma_f32_32x32x16_bf16 v[80:95], v[96:99], v[140:143], v[80:95]
  ds_read_b128 v[140:143], v149 offset:8192
  ds_read_b64_tr_b16 v[116:117], v152 offset:17664
  ds_read_b64_tr_b16 v[118:119], v152 offset:17920
  s_waitcnt lgkmcnt(8)
  v_mfma_f32_32x32x16_bf16 v[80:95], v[100:103], v[144:147], v[80:95]
  ds_read_b128 v[144:147], v150 offset:8192
  ds_read_b64_tr_b16 v[120:121], v152 offset:18688
  ds_read_b64_tr_b16 v[122:123], v152 offset:18944
  s_waitcnt lgkmcnt(10)
  v_mfma_f32_32x32x16_bf16 v[80:95], v[104:107], v[128:131], v[80:95]
  ds_read_b128 v[128:131], v151 offset:8192
  ds_read_b64_tr_b16 v[124:125], v152 offset:19712
  ds_read_b64_tr_b16 v[126:127], v152 offset:19968
  s_waitcnt lgkmcnt(12)
  v_mfma_f32_32x32x16_bf16 v[80:95], v[108:111], v[132:135], v[80:95]
  ds_read_b128 v[132:135], v148 offset:12288
  s_waitcnt lgkmcnt(10)
  v_mfma_f32_32x32x16_bf16 v[0:15], v[112:115], v[136:139], v[0:15]
  ds_read_b128 v[136:139], v149 offset:12288
  s_waitcnt lgkmcnt(8)
  v_mfma_f32_32x32x16_bf16 v[0:15], v[116:119], v[140:143], v[0:15]
  ds_read_b128 v[140:143], v150 offset:12288
  s_waitcnt lgkmcnt(6)
  v_mfma_f32_32x32x16_bf16 v[0:15], v[120:123], v[144:147], v[0:15]
  ds_read_b128 v[144:147], v151 offset:12288
  s_waitcnt lgkmcnt(4)
  v_mfma_f32_32x32x16_bf16 v[0:15], v[124:127], v[128:131], v[0:15]
  ds_read_b128 v[128:131], v148 offset:16384
  s_waitcnt lgkmcnt(4)
  v_mfma_f32_32x32x16_bf16 v[16:31], v[112:115], v[132:135], v[16:31]
  ds_read_b128 v[132:135], v149 offset:16384
  s_waitcnt lgkmcnt(4)
  v_mfma_f32_32x32x16_bf16 v[16:31], v[116:119], v[136:139], v[16:31]
  ds_read_b128 v[136:139], v150 offset:16384
  s_waitcnt lgkmcnt(4)
  v_mfma_f32_32x32x16_bf16 v[16:31], v[120:123], v[140:143], v[16:31]
  ds_read_b128 v[140:143], v151 offset:16384
  s_waitcnt lgkmcnt(4)
  v_mfma_f32_32x32x16_bf16 v[16:31], v[124:127], v[144:147], v[16:31]
  ds_read_b128 v[144:147], v148 offset:20480
  s_waitcnt lgkmcnt(4)
  v_mfma_f32_32x32x16_bf16 v[32:47], v[112:115], v[128:131], v[32:47]
  ds_read_b128 v[128:131], v149 offset:20480
  s_waitcnt lgkmcnt(4)
  v_mfma_f32_32x32x16_bf16 v[32:47], v[116:119], v[132:135], v[32:47]
  ds_read_b128 v[132:135], v150 offset:20480
  s_waitcnt lgkmcnt(4)
  v_mfma_f32_32x32x16_bf16 v[32:47], v[120:123], v[136:139], v[32:47]
  ds_read_b128 v[136:139], v151 offset:20480
  s_waitcnt lgkmcnt(4)
  v_mfma_f32_32x32x16_bf16 v[32:47], v[124:127], v[140:143], v[32:47]
  ds_read_b128 v[140:143], v148 offset:24576
  s_waitcnt lgkmcnt(4)
  v_mfma_f32_32x32x16_bf16 v[48:63], v[112:115], v[144:147], v[48:63]
  ds_read_b128 v[144:147], v149 offset:24576
  s_waitcnt lgkmcnt(4)
  v_mfma_f32_32x32x16_bf16 v[48:63], v[116:119], v[128:131], v[48:63]
  ds_read_b128 v[128:131], v150 offset:24576
  s_waitcnt lgkmcnt(4)
  v_mfma_f32_32x32x16_bf16 v[48:63], v[120:123], v[132:135], v[48:63]
  ds_read_b128 v[132:135], v151 offset:24576
  s_waitcnt lgkmcnt(4)
  v_mfma_f32_32x32x16_bf16 v[48:63], v[124:127], v[136:139], v[48:63]
  ds_read_b128 v[136:139], v148 offset:28672
  s_waitcnt lgkmcnt(4)
  v_mfma_f32_32x32x16_bf16 v[64:79], v[112:115], v[140:143], v[64:79]
  ds_read_b128 v[140:143], v149 offset:28672
  s_waitcnt lgkmcnt(4)
  v_mfma_f32_32x32x16_bf16 v[64:79], v[116:119], v[144:147], v[64:79]
  ds_read_b128 v[144:147], v150 offset:28672
  s_waitcnt lgkmcnt(4)
  v_mfma_f32_32x32x16_bf16 v[64:79], v[120:123], v[128:131], v[64:79]
  ds_read_b128 v[128:131], v151 offset:28672
  s_waitcnt lgkmcnt(4)
  v_mfma_f32_32x32x16_bf16 v[64:79], v[124:127], v[132:135], v[64:79]
  s_barrier
  ds_read_b128 v[132:135], v148 offset:32768
  ds_read_b64_tr_b16 v[96:97], v152 offset:0
  ds_read_b64_tr_b16 v[98:99], v152 offset:256
  s_waitcnt lgkmcnt(6)
  v_mfma_f32_32x32x16_bf16 v[80:95], v[112:115], v[136:139], v[80:95]
  ds_read_b128 v[136:139], v149 offset:32768
  ds_read_b64_tr_b16 v[100:101], v152 offset:1024
  ds_read_b64_tr_b16 v[102:103], v152 offset:1280
  s_waitcnt lgkmcnt(8)
  v_mfma_f32_32x32x16_bf16 v[80:95], v[116:119], v[140:143], v[80:95]
  ds_read_b128 v[140:143], v150 offset:32768
  ds_read_b64_tr_b16 v[104:105], v152 offset:2048
  ds_read_b64_tr_b16 v[106:107], v152 offset:2304
  s_waitcnt lgkmcnt(10)
  v_mfma_f32_32x32x16_bf16 v[80:95], v[120:123], v[144:147], v[80:95]
  ds_read_b128 v[144:147], v151 offset:32768
  ds_read_b64_tr_b16 v[108:109], v152 offset:3072
  ds_read_b64_tr_b16 v[110:111], v152 offset:3328
  s_waitcnt lgkmcnt(12)
  v_mfma_f32_32x32x16_bf16 v[80:95], v[124:127], v[128:131], v[80:95]
  ds_read_b128 v[128:131], v148 offset:36864
  s_waitcnt lgkmcnt(10)
  v_mfma_f32_32x32x16_bf16 v[0:15], v[96:99], v[132:135], v[0:15]
  ds_read_b128 v[132:135], v149 offset:36864
  s_waitcnt lgkmcnt(8)
  v_mfma_f32_32x32x16_bf16 v[0:15], v[100:103], v[136:139], v[0:15]
  ds_read_b128 v[136:139], v150 offset:36864
  s_waitcnt lgkmcnt(6)
  v_mfma_f32_32x32x16_bf16 v[0:15], v[104:107], v[140:143], v[0:15]
  ds_read_b128 v[140:143], v151 offset:36864
  s_waitcnt lgkmcnt(4)
  v_mfma_f32_32x32x16_bf16 v[0:15], v[108:111], v[144:147], v[0:15]
  ds_read_b128 v[144:147], v148 offset:40960
  s_waitcnt lgkmcnt(4)
  v_mfma_f32_32x32x16_bf16 v[16:31], v[96:99], v[128:131], v[16:31]
  ds_read_b128 v[128:131], v149 offset:40960
  s_waitcnt lgkmcnt(4)
  v_mfma_f32_32x32x16_bf16 v[16:31], v[100:103], v[132:135], v[16:31]
  ds_read_b128 v[132:135], v150 offset:40960
  s_waitcnt lgkmcnt(4)
  v_mfma_f32_32x32x16_bf16 v[16:31], v[104:107], v[136:139], v[16:31]
  ds_read_b128 v[136:139], v151 offset:40960
  s_waitcnt lgkmcnt(4)
  v_mfma_f32_32x32x16_bf16 v[16:31], v[108:111], v[140:143], v[16:31]
  ds_read_b128 v[140:143], v148 offset:45056
  s_waitcnt lgkmcnt(4)
  v_mfma_f32_32x32x16_bf16 v[32:47], v[96:99], v[144:147], v[32:47]
  ds_read_b128 v[144:147], v149 offset:45056
  s_waitcnt lgkmcnt(4)
  v_mfma_f32_32x32x16_bf16 v[32:47], v[100:103], v[128:131], v[32:47]
  ds_read_b128 v[128:131], v150 offset:45056
  s_waitcnt lgkmcnt(4)
  v_mfma_f32_32x32x16_bf16 v[32:47], v[104:107], v[132:135], v[32:47]
  ds_read_b128 v[132:135], v151 offset:45056
  s_waitcnt lgkmcnt(4)
  v_mfma_f32_32x32x16_bf16 v[32:47], v[108:111], v[136:139], v[32:47]
  ds_read_b128 v[136:139], v148 offset:49152
  s_waitcnt lgkmcnt(4)
  v_mfma_f32_32x32x16_bf16 v[48:63], v[96:99], v[140:143], v[48:63]
  ds_read_b128 v[140:143], v149 offset:49152
  s_waitcnt lgkmcnt(4)
  v_mfma_f32_32x32x16_bf16 v[48:63], v[100:103], v[144:147], v[48:63]
  ds_read_b128 v[144:147], v150 offset:49152
  s_waitcnt lgkmcnt(4)
  v_mfma_f32_32x32x16_bf16 v[48:63], v[104:107], v[128:131], v[48:63]
  ds_read_b128 v[128:131], v151 offset:49152
  s_waitcnt lgkmcnt(4)
  v_mfma_f32_32x32x16_bf16 v[48:63], v[108:111], v[132:135], v[48:63]
  ds_read_b128 v[132:135], v148 offset:53248
  s_waitcnt lgkmcnt(4)
  v_mfma_f32_32x32x16_bf16 v[64:79], v[96:99], v[136:139], v[64:79]
  ds_read_b128 v[136:139], v149 offset:53248
  s_waitcnt lgkmcnt(4)
  v_mfma_f32_32x32x16_bf16 v[64:79], v[100:103], v[140:143], v[64:79]
  ds_read_b128 v[140:143], v150 offset:53248
  s_waitcnt lgkmcnt(4)
  v_mfma_f32_32x32x16_bf16 v[64:79], v[104:107], v[144:147], v[64:79]
  ds_read_b128 v[144:147], v151 offset:53248
  s_waitcnt lgkmcnt(4)
  v_mfma_f32_32x32x16_bf16 v[64:79], v[108:111], v[128:131], v[64:79]
  s_barrier
  ds_read_b128 v[128:131], v148 offset:57344
  ds_read_b64_tr_b16 v[112:113], v152 offset:16640
  ds_read_b64_tr_b16 v[114:115], v152 offset:16896
  s_waitcnt lgkmcnt(6)
  v_mfma_f32_32x32x16_bf16 v[80:95], v[96:99], v[132:135], v[80:95]
  ds_read_b128 v[132:135], v149 offset:57344
  ds_read_b64_tr_b16 v[116:117], v152 offset:17664
  ds_read_b64_tr_b16 v[118:119], v152 offset:17920
  s_waitcnt lgkmcnt(8)
  v_mfma_f32_32x32x16_bf16 v[80:95], v[100:103], v[136:139], v[80:95]
  ds_read_b128 v[136:139], v150 offset:57344
  ds_read_b64_tr_b16 v[120:121], v152 offset:18688
  ds_read_b64_tr_b16 v[122:123], v152 offset:18944
  s_waitcnt lgkmcnt(10)
  v_mfma_f32_32x32x16_bf16 v[80:95], v[104:107], v[140:143], v[80:95]
  ds_read_b128 v[140:143], v151 offset:57344
  ds_read_b64_tr_b16 v[124:125], v152 offset:19712
  ds_read_b64_tr_b16 v[126:127], v152 offset:19968
  s_waitcnt lgkmcnt(12)
  v_mfma_f32_32x32x16_bf16 v[80:95], v[108:111], v[144:147], v[80:95]
  v_xor_b32 v148, 0x10000, v148
  ds_read_b128 v[144:147], v148 offset:0
  s_waitcnt lgkmcnt(10)
  v_mfma_f32_32x32x16_bf16 v[0:15], v[112:115], v[128:131], v[0:15]
  v_xor_b32 v149, 0x10000, v149
  ds_read_b128 v[128:131], v149 offset:0
  s_waitcnt lgkmcnt(8)
  v_mfma_f32_32x32x16_bf16 v[0:15], v[116:119], v[132:135], v[0:15]
  v_xor_b32 v150, 0x10000, v150
  ds_read_b128 v[132:135], v150 offset:0
  s_waitcnt lgkmcnt(6)
  v_mfma_f32_32x32x16_bf16 v[0:15], v[120:123], v[136:139], v[0:15]
  v_xor_b32 v151, 0x10000, v151
  ds_read_b128 v[136:139], v151 offset:0
  s_waitcnt lgkmcnt(4)
  v_mfma_f32_32x32x16_bf16 v[0:15], v[124:127], v[140:143], v[0:15]
  ds_read_b128 v[140:143], v148 offset:4096
  s_waitcnt lgkmcnt(4)
  v_mfma_f32_32x32x16_bf16 v[16:31], v[112:115], v[144:147], v[16:31]
  ds_read_b128 v[144:147], v149 offset:4096
  s_waitcnt lgkmcnt(4)
  v_mfma_f32_32x32x16_bf16 v[16:31], v[116:119], v[128:131], v[16:31]
  ds_read_b128 v[128:131], v150 offset:4096
  s_waitcnt lgkmcnt(4)
  v_mfma_f32_32x32x16_bf16 v[16:31], v[120:123], v[132:135], v[16:31]
  ds_read_b128 v[132:135], v151 offset:4096
  s_waitcnt lgkmcnt(4)
  v_mfma_f32_32x32x16_bf16 v[16:31], v[124:127], v[136:139], v[16:31]
  ds_read_b128 v[136:139], v148 offset:8192
  s_waitcnt lgkmcnt(4)
  v_mfma_f32_32x32x16_bf16 v[32:47], v[112:115], v[140:143], v[32:47]
  ds_read_b128 v[140:143], v149 offset:8192
  s_waitcnt lgkmcnt(4)
  v_mfma_f32_32x32x16_bf16 v[32:47], v[116:119], v[144:147], v[32:47]
  ds_read_b128 v[144:147], v150 offset:8192
  s_waitcnt lgkmcnt(4)
  v_mfma_f32_32x32x16_bf16 v[32:47], v[120:123], v[128:131], v[32:47]
  ds_read_b128 v[128:131], v151 offset:8192
  s_waitcnt lgkmcnt(4)
  v_mfma_f32_32x32x16_bf16 v[32:47], v[124:127], v[132:135], v[32:47]
  ds_read_b128 v[132:135], v148 offset:12288
  s_waitcnt lgkmcnt(4)
  v_mfma_f32_32x32x16_bf16 v[48:63], v[112:115], v[136:139], v[48:63]
  ds_read_b128 v[136:139], v149 offset:12288
  s_waitcnt lgkmcnt(4)
  v_mfma_f32_32x32x16_bf16 v[48:63], v[116:119], v[140:143], v[48:63]
  ds_read_b128 v[140:143], v150 offset:12288
  s_waitcnt lgkmcnt(4)
  v_mfma_f32_32x32x16_bf16 v[48:63], v[120:123], v[144:147], v[48:63]
  ds_read_b128 v[144:147], v151 offset:12288
  s_waitcnt lgkmcnt(4)
  v_mfma_f32_32x32x16_bf16 v[48:63], v[124:127], v[128:131], v[48:63]
  ds_read_b128 v[128:131], v148 offset:16384
  s_waitcnt lgkmcnt(4)
  v_mfma_f32_32x32x16_bf16 v[64:79], v[112:115], v[132:135], v[64:79]
  ds_read_b128 v[132:135], v149 offset:16384
  s_waitcnt lgkmcnt(4)
  v_mfma_f32_32x32x16_bf16 v[64:79], v[116:119], v[136:139], v[64:79]
  ds_read_b128 v[136:139], v150 offset:16384
  s_waitcnt lgkmcnt(4)
  v_mfma_f32_32x32x16_bf16 v[64:79], v[120:123], v[140:143], v[64:79]
  ds_read_b128 v[140:143], v151 offset:16384
  s_waitcnt lgkmcnt(4)
  v_mfma_f32_32x32x16_bf16 v[64:79], v[124:127], v[144:147], v[64:79]
  s_barrier
  ds_read_b128 v[144:147], v148 offset:20480
  ds_read_b64_tr_b16 v[96:97], v152 offset:0
  ds_read_b64_tr_b16 v[98:99], v152 offset:256
  s_waitcnt lgkmcnt(6)
  v_mfma_f32_32x32x16_bf16 v[80:95], v[112:115], v[128:131], v[80:95]
  ds_read_b128 v[128:131], v149 offset:20480
  ds_read_b64_tr_b16 v[100:101], v152 offset:1024
  ds_read_b64_tr_b16 v[102:103], v152 offset:1280
  s_waitcnt lgkmcnt(8)
  v_mfma_f32_32x32x16_bf16 v[80:95], v[116:119], v[132:135], v[80:95]
  ds_read_b128 v[132:135], v150 offset:20480
  ds_read_b64_tr_b16 v[104:105], v152 offset:2048
  ds_read_b64_tr_b16 v[106:107], v152 offset:2304
  s_waitcnt lgkmcnt(10)
  v_mfma_f32_32x32x16_bf16 v[80:95], v[120:123], v[136:139], v[80:95]
  ds_read_b128 v[136:139], v151 offset:20480
  ds_read_b64_tr_b16 v[108:109], v152 offset:3072
  ds_read_b64_tr_b16 v[110:111], v152 offset:3328
  s_waitcnt lgkmcnt(12)
  v_mfma_f32_32x32x16_bf16 v[80:95], v[124:127], v[140:143], v[80:95]
  ds_read_b128 v[140:143], v148 offset:24576
  s_waitcnt lgkmcnt(10)
  v_mfma_f32_32x32x16_bf16 v[0:15], v[96:99], v[144:147], v[0:15]
  ds_read_b128 v[144:147], v149 offset:24576
  s_waitcnt lgkmcnt(8)
  v_mfma_f32_32x32x16_bf16 v[0:15], v[100:103], v[128:131], v[0:15]
  ds_read_b128 v[128:131], v150 offset:24576
  s_waitcnt lgkmcnt(6)
  v_mfma_f32_32x32x16_bf16 v[0:15], v[104:107], v[132:135], v[0:15]
  ds_read_b128 v[132:135], v151 offset:24576
  s_waitcnt lgkmcnt(4)
  v_mfma_f32_32x32x16_bf16 v[0:15], v[108:111], v[136:139], v[0:15]
  ds_read_b128 v[136:139], v148 offset:28672
  s_waitcnt lgkmcnt(4)
  v_mfma_f32_32x32x16_bf16 v[16:31], v[96:99], v[140:143], v[16:31]
  ds_read_b128 v[140:143], v149 offset:28672
  s_waitcnt lgkmcnt(4)
  v_mfma_f32_32x32x16_bf16 v[16:31], v[100:103], v[144:147], v[16:31]
  ds_read_b128 v[144:147], v150 offset:28672
  s_waitcnt lgkmcnt(4)
  v_mfma_f32_32x32x16_bf16 v[16:31], v[104:107], v[128:131], v[16:31]
  ds_read_b128 v[128:131], v151 offset:28672
  s_waitcnt lgkmcnt(4)
  v_mfma_f32_32x32x16_bf16 v[16:31], v[108:111], v[132:135], v[16:31]
  ds_read_b128 v[132:135], v148 offset:32768
  s_waitcnt lgkmcnt(4)
  v_mfma_f32_32x32x16_bf16 v[32:47], v[96:99], v[136:139], v[32:47]
  ds_read_b128 v[136:139], v149 offset:32768
  s_waitcnt lgkmcnt(4)
  v_mfma_f32_32x32x16_bf16 v[32:47], v[100:103], v[140:143], v[32:47]
  ds_read_b128 v[140:143], v150 offset:32768
  s_waitcnt lgkmcnt(4)
  v_mfma_f32_32x32x16_bf16 v[32:47], v[104:107], v[144:147], v[32:47]
  ds_read_b128 v[144:147], v151 offset:32768
  s_waitcnt lgkmcnt(4)
  v_mfma_f32_32x32x16_bf16 v[32:47], v[108:111], v[128:131], v[32:47]
  ds_read_b128 v[128:131], v148 offset:36864
  s_waitcnt lgkmcnt(4)
  v_mfma_f32_32x32x16_bf16 v[48:63], v[96:99], v[132:135], v[48:63]
  ds_read_b128 v[132:135], v149 offset:36864
  s_waitcnt lgkmcnt(4)
  v_mfma_f32_32x32x16_bf16 v[48:63], v[100:103], v[136:139], v[48:63]
  ds_read_b128 v[136:139], v150 offset:36864
  s_waitcnt lgkmcnt(4)
  v_mfma_f32_32x32x16_bf16 v[48:63], v[104:107], v[140:143], v[48:63]
  ds_read_b128 v[140:143], v151 offset:36864
  s_waitcnt lgkmcnt(4)
  v_mfma_f32_32x32x16_bf16 v[48:63], v[108:111], v[144:147], v[48:63]
  ds_read_b128 v[144:147], v148 offset:40960
  s_waitcnt lgkmcnt(4)
  v_mfma_f32_32x32x16_bf16 v[64:79], v[96:99], v[128:131], v[64:79]
  ds_read_b128 v[128:131], v149 offset:40960
  s_waitcnt lgkmcnt(4)
  v_mfma_f32_32x32x16_bf16 v[64:79], v[100:103], v[132:135], v[64:79]
  ds_read_b128 v[132:135], v150 offset:40960
  s_waitcnt lgkmcnt(4)
  v_mfma_f32_32x32x16_bf16 v[64:79], v[104:107], v[136:139], v[64:79]
  ds_read_b128 v[136:139], v151 offset:40960
  s_waitcnt lgkmcnt(4)
  v_mfma_f32_32x32x16_bf16 v[64:79], v[108:111], v[140:143], v[64:79]
  s_barrier
  ds_read_b128 v[140:143], v148 offset:45056
  ds_read_b64_tr_b16 v[112:113], v152 offset:16640
  ds_read_b64_tr_b16 v[114:115], v152 offset:16896
  s_waitcnt lgkmcnt(6)
  v_mfma_f32_32x32x16_bf16 v[80:95], v[96:99], v[144:147], v[80:95]
  ds_read_b128 v[144:147], v149 offset:45056
  ds_read_b64_tr_b16 v[116:117], v152 offset:17664
  ds_read_b64_tr_b16 v[118:119], v152 offset:17920
  s_waitcnt lgkmcnt(8)
  v_mfma_f32_32x32x16_bf16 v[80:95], v[100:103], v[128:131], v[80:95]
  ds_read_b128 v[128:131], v150 offset:45056
  ds_read_b64_tr_b16 v[120:121], v152 offset:18688
  ds_read_b64_tr_b16 v[122:123], v152 offset:18944
  s_waitcnt lgkmcnt(10)
  v_mfma_f32_32x32x16_bf16 v[80:95], v[104:107], v[132:135], v[80:95]
  ds_read_b128 v[132:135], v151 offset:45056
  ds_read_b64_tr_b16 v[124:125], v152 offset:19712
  ds_read_b64_tr_b16 v[126:127], v152 offset:19968
  s_waitcnt lgkmcnt(12)
  v_mfma_f32_32x32x16_bf16 v[80:95], v[108:111], v[136:139], v[80:95]
  ds_read_b128 v[136:139], v148 offset:49152
  s_waitcnt lgkmcnt(10)
  v_mfma_f32_32x32x16_bf16 v[0:15], v[112:115], v[140:143], v[0:15]
  ds_read_b128 v[140:143], v149 offset:49152
  s_waitcnt lgkmcnt(8)
  v_mfma_f32_32x32x16_bf16 v[0:15], v[116:119], v[144:147], v[0:15]
  ds_read_b128 v[144:147], v150 offset:49152
  s_waitcnt lgkmcnt(6)
  v_mfma_f32_32x32x16_bf16 v[0:15], v[120:123], v[128:131], v[0:15]
  ds_read_b128 v[128:131], v151 offset:49152
  s_waitcnt lgkmcnt(4)
  v_mfma_f32_32x32x16_bf16 v[0:15], v[124:127], v[132:135], v[0:15]
  ds_read_b128 v[132:135], v148 offset:53248
  s_waitcnt lgkmcnt(4)
  v_mfma_f32_32x32x16_bf16 v[16:31], v[112:115], v[136:139], v[16:31]
  ds_read_b128 v[136:139], v149 offset:53248
  s_waitcnt lgkmcnt(4)
  v_mfma_f32_32x32x16_bf16 v[16:31], v[116:119], v[140:143], v[16:31]
  ds_read_b128 v[140:143], v150 offset:53248
  s_waitcnt lgkmcnt(4)
  v_mfma_f32_32x32x16_bf16 v[16:31], v[120:123], v[144:147], v[16:31]
  ds_read_b128 v[144:147], v151 offset:53248
  s_waitcnt lgkmcnt(4)
  v_mfma_f32_32x32x16_bf16 v[16:31], v[124:127], v[128:131], v[16:31]
  ds_read_b128 v[128:131], v148 offset:57344
  s_waitcnt lgkmcnt(4)
  v_mfma_f32_32x32x16_bf16 v[32:47], v[112:115], v[132:135], v[32:47]
  ds_read_b128 v[132:135], v149 offset:57344
  s_waitcnt lgkmcnt(4)
  v_mfma_f32_32x32x16_bf16 v[32:47], v[116:119], v[136:139], v[32:47]
  ds_read_b128 v[136:139], v150 offset:57344
  s_waitcnt lgkmcnt(4)
  v_mfma_f32_32x32x16_bf16 v[32:47], v[120:123], v[140:143], v[32:47]
  ds_read_b128 v[140:143], v151 offset:57344
  s_waitcnt lgkmcnt(4)
  v_mfma_f32_32x32x16_bf16 v[32:47], v[124:127], v[144:147], v[32:47]
  ds_read_b128 v[144:147], v148 offset:61440
  s_waitcnt lgkmcnt(4)
  v_mfma_f32_32x32x16_bf16 v[48:63], v[112:115], v[128:131], v[48:63]
  ds_read_b128 v[128:131], v149 offset:61440
  s_waitcnt lgkmcnt(4)
  v_mfma_f32_32x32x16_bf16 v[48:63], v[116:119], v[132:135], v[48:63]
  ds_read_b128 v[132:135], v150 offset:61440
  s_waitcnt lgkmcnt(4)
  v_mfma_f32_32x32x16_bf16 v[48:63], v[120:123], v[136:139], v[48:63]
  ds_read_b128 v[136:139], v151 offset:61440
  s_waitcnt lgkmcnt(4)
  v_mfma_f32_32x32x16_bf16 v[48:63], v[124:127], v[140:143], v[48:63]
  v_xor_b32 v148, 0x10000, v148
  ds_read_b128 v[140:143], v148 offset:0
  s_waitcnt lgkmcnt(4)
  v_mfma_f32_32x32x16_bf16 v[64:79], v[112:115], v[144:147], v[64:79]
  v_xor_b32 v149, 0x10000, v149
  ds_read_b128 v[144:147], v149 offset:0
  s_waitcnt lgkmcnt(4)
  v_mfma_f32_32x32x16_bf16 v[64:79], v[116:119], v[128:131], v[64:79]
  v_xor_b32 v150, 0x10000, v150
  ds_read_b128 v[128:131], v150 offset:0
  s_waitcnt lgkmcnt(4)
  v_mfma_f32_32x32x16_bf16 v[64:79], v[120:123], v[132:135], v[64:79]
  v_xor_b32 v151, 0x10000, v151
  ds_read_b128 v[132:135], v151 offset:0
  s_waitcnt lgkmcnt(4)
  v_mfma_f32_32x32x16_bf16 v[64:79], v[124:127], v[136:139], v[64:79]
  s_barrier
  ds_read_b128 v[136:139], v148 offset:4096
  ds_read_b64_tr_b16 v[96:97], v152 offset:0
  ds_read_b64_tr_b16 v[98:99], v152 offset:256
  s_waitcnt lgkmcnt(6)
  v_mfma_f32_32x32x16_bf16 v[80:95], v[112:115], v[140:143], v[80:95]
  ds_read_b128 v[140:143], v149 offset:4096
  ds_read_b64_tr_b16 v[100:101], v152 offset:1024
  ds_read_b64_tr_b16 v[102:103], v152 offset:1280
  s_waitcnt lgkmcnt(8)
  v_mfma_f32_32x32x16_bf16 v[80:95], v[116:119], v[144:147], v[80:95]
  ds_read_b128 v[144:147], v150 offset:4096
  ds_read_b64_tr_b16 v[104:105], v152 offset:2048
  ds_read_b64_tr_b16 v[106:107], v152 offset:2304
  s_waitcnt lgkmcnt(10)
  v_mfma_f32_32x32x16_bf16 v[80:95], v[120:123], v[128:131], v[80:95]
  ds_read_b128 v[128:131], v151 offset:4096
  ds_read_b64_tr_b16 v[108:109], v152 offset:3072
  ds_read_b64_tr_b16 v[110:111], v152 offset:3328
  s_waitcnt lgkmcnt(12)
  v_mfma_f32_32x32x16_bf16 v[80:95], v[124:127], v[132:135], v[80:95]
  ds_read_b128 v[132:135], v148 offset:8192
  s_waitcnt lgkmcnt(10)
  v_mfma_f32_32x32x16_bf16 v[0:15], v[96:99], v[136:139], v[0:15]
  ds_read_b128 v[136:139], v149 offset:8192
  s_waitcnt lgkmcnt(8)
  v_mfma_f32_32x32x16_bf16 v[0:15], v[100:103], v[140:143], v[0:15]
  ds_read_b128 v[140:143], v150 offset:8192
  s_waitcnt lgkmcnt(6)
  v_mfma_f32_32x32x16_bf16 v[0:15], v[104:107], v[144:147], v[0:15]
  ds_read_b128 v[144:147], v151 offset:8192
  s_waitcnt lgkmcnt(4)
  v_mfma_f32_32x32x16_bf16 v[0:15], v[108:111], v[128:131], v[0:15]
  ds_read_b128 v[128:131], v148 offset:12288
  s_waitcnt lgkmcnt(4)
  v_mfma_f32_32x32x16_bf16 v[16:31], v[96:99], v[132:135], v[16:31]
  ds_read_b128 v[132:135], v149 offset:12288
  s_waitcnt lgkmcnt(4)
  v_mfma_f32_32x32x16_bf16 v[16:31], v[100:103], v[136:139], v[16:31]
  ds_read_b128 v[136:139], v150 offset:12288
  s_waitcnt lgkmcnt(4)
  v_mfma_f32_32x32x16_bf16 v[16:31], v[104:107], v[140:143], v[16:31]
  ds_read_b128 v[140:143], v151 offset:12288
  s_waitcnt lgkmcnt(4)
  v_mfma_f32_32x32x16_bf16 v[16:31], v[108:111], v[144:147], v[16:31]
  ds_read_b128 v[144:147], v148 offset:16384
  s_waitcnt lgkmcnt(4)
  v_mfma_f32_32x32x16_bf16 v[32:47], v[96:99], v[128:131], v[32:47]
  ds_read_b128 v[128:131], v149 offset:16384
  s_waitcnt lgkmcnt(4)
  v_mfma_f32_32x32x16_bf16 v[32:47], v[100:103], v[132:135], v[32:47]
  ds_read_b128 v[132:135], v150 offset:16384
  s_waitcnt lgkmcnt(4)
  v_mfma_f32_32x32x16_bf16 v[32:47], v[104:107], v[136:139], v[32:47]
  ds_read_b128 v[136:139], v151 offset:16384
  s_waitcnt lgkmcnt(4)
  v_mfma_f32_32x32x16_bf16 v[32:47], v[108:111], v[140:143], v[32:47]
  ds_read_b128 v[140:143], v148 offset:20480
  s_waitcnt lgkmcnt(4)
  v_mfma_f32_32x32x16_bf16 v[48:63], v[96:99], v[144:147], v[48:63]
  ds_read_b128 v[144:147], v149 offset:20480
  s_waitcnt lgkmcnt(4)
  v_mfma_f32_32x32x16_bf16 v[48:63], v[100:103], v[128:131], v[48:63]
  ds_read_b128 v[128:131], v150 offset:20480
  s_waitcnt lgkmcnt(4)
  v_mfma_f32_32x32x16_bf16 v[48:63], v[104:107], v[132:135], v[48:63]
  ds_read_b128 v[132:135], v151 offset:20480
  s_waitcnt lgkmcnt(4)
  v_mfma_f32_32x32x16_bf16 v[48:63], v[108:111], v[136:139], v[48:63]
  ds_read_b128 v[136:139], v148 offset:24576
  s_waitcnt lgkmcnt(4)
  v_mfma_f32_32x32x16_bf16 v[64:79], v[96:99], v[140:143], v[64:79]
  ds_read_b128 v[140:143], v149 offset:24576
  s_waitcnt lgkmcnt(4)
  v_mfma_f32_32x32x16_bf16 v[64:79], v[100:103], v[144:147], v[64:79]
  ds_read_b128 v[144:147], v150 offset:24576
  s_waitcnt lgkmcnt(4)
  v_mfma_f32_32x32x16_bf16 v[64:79], v[104:107], v[128:131], v[64:79]
  ds_read_b128 v[128:131], v151 offset:24576
  s_waitcnt lgkmcnt(4)
  v_mfma_f32_32x32x16_bf16 v[64:79], v[108:111], v[132:135], v[64:79]
  s_barrier
  ds_read_b128 v[132:135], v148 offset:28672
  ds_read_b64_tr_b16 v[112:113], v152 offset:16640
  ds_read_b64_tr_b16 v[114:115], v152 offset:16896
  s_waitcnt lgkmcnt(6)
  v_mfma_f32_32x32x16_bf16 v[80:95], v[96:99], v[136:139], v[80:95]
  ds_read_b128 v[136:139], v149 offset:28672
  ds_read_b64_tr_b16 v[116:117], v152 offset:17664
  ds_read_b64_tr_b16 v[118:119], v152 offset:17920
  s_waitcnt lgkmcnt(8)
  v_mfma_f32_32x32x16_bf16 v[80:95], v[100:103], v[140:143], v[80:95]
  ds_read_b128 v[140:143], v150 offset:28672
  ds_read_b64_tr_b16 v[120:121], v152 offset:18688
  ds_read_b64_tr_b16 v[122:123], v152 offset:18944
  s_waitcnt lgkmcnt(10)
  v_mfma_f32_32x32x16_bf16 v[80:95], v[104:107], v[144:147], v[80:95]
  ds_read_b128 v[144:147], v151 offset:28672
  ds_read_b64_tr_b16 v[124:125], v152 offset:19712
  ds_read_b64_tr_b16 v[126:127], v152 offset:19968
  s_waitcnt lgkmcnt(12)
  v_mfma_f32_32x32x16_bf16 v[80:95], v[108:111], v[128:131], v[80:95]
  ds_read_b128 v[128:131], v148 offset:32768
  s_waitcnt lgkmcnt(10)
  v_mfma_f32_32x32x16_bf16 v[0:15], v[112:115], v[132:135], v[0:15]
  ds_read_b128 v[132:135], v149 offset:32768
  s_waitcnt lgkmcnt(8)
  v_mfma_f32_32x32x16_bf16 v[0:15], v[116:119], v[136:139], v[0:15]
  ds_read_b128 v[136:139], v150 offset:32768
  s_waitcnt lgkmcnt(6)
  v_mfma_f32_32x32x16_bf16 v[0:15], v[120:123], v[140:143], v[0:15]
  ds_read_b128 v[140:143], v151 offset:32768
  s_waitcnt lgkmcnt(4)
  v_mfma_f32_32x32x16_bf16 v[0:15], v[124:127], v[144:147], v[0:15]
  ds_read_b128 v[144:147], v148 offset:36864
  s_waitcnt lgkmcnt(4)
  v_mfma_f32_32x32x16_bf16 v[16:31], v[112:115], v[128:131], v[16:31]
  ds_read_b128 v[128:131], v149 offset:36864
  s_waitcnt lgkmcnt(4)
  v_mfma_f32_32x32x16_bf16 v[16:31], v[116:119], v[132:135], v[16:31]
  ds_read_b128 v[132:135], v150 offset:36864
  v_cvt_pk_bf16_f32 v0, v0, v1
  v_cvt_pk_bf16_f32 v1, v2, v3
  v_cvt_pk_bf16_f32 v2, v4, v5
  v_cvt_pk_bf16_f32 v3, v6, v7
  v_cvt_pk_bf16_f32 v4, v8, v9
  v_cvt_pk_bf16_f32 v5, v10, v11
  v_permlane32_swap_b32 v0, v2
  v_permlane32_swap_b32 v1, v3
  s_waitcnt lgkmcnt(4)
  v_mfma_f32_32x32x16_bf16 v[16:31], v[120:123], v[136:139], v[16:31]
  ds_read_b128 v[136:139], v151 offset:36864
  v_cvt_pk_bf16_f32 v6, v12, v13
  ds_write_b128 v154, v[0:3] offset:0
  v_cvt_pk_bf16_f32 v7, v14, v15
  v_xor_b32 v8, 32, v154
  s_nop 0
  v_permlane32_swap_b32 v4, v6
  v_permlane32_swap_b32 v5, v7
  ds_write_b128 v8, v[4:7] offset:0
  s_waitcnt lgkmcnt(6)
  v_mfma_f32_32x32x16_bf16 v[16:31], v[124:127], v[140:143], v[16:31]
  ds_read_b128 v[140:143], v148 offset:40960
  ds_write_b8 v153, v155 offset:0
  s_waitcnt lgkmcnt(7)
  v_mfma_f32_32x32x16_bf16 v[32:47], v[112:115], v[144:147], v[32:47]
  ds_read_b128 v[144:147], v149 offset:40960
  s_waitcnt lgkmcnt(7)
  v_mfma_f32_32x32x16_bf16 v[32:47], v[116:119], v[128:131], v[32:47]
  ds_read_b128 v[128:131], v150 offset:40960
  v_cvt_pk_bf16_f32 v16, v16, v17
  v_cvt_pk_bf16_f32 v17, v18, v19
  v_cvt_pk_bf16_f32 v18, v20, v21
  v_cvt_pk_bf16_f32 v19, v22, v23
  v_cvt_pk_bf16_f32 v20, v24, v25
  v_cvt_pk_bf16_f32 v21, v26, v27
  v_permlane32_swap_b32 v16, v18
  v_permlane32_swap_b32 v17, v19
  s_waitcnt lgkmcnt(7)
  v_mfma_f32_32x32x16_bf16 v[32:47], v[120:123], v[132:135], v[32:47]
  ds_read_b128 v[132:135], v151 offset:40960
  v_cvt_pk_bf16_f32 v22, v28, v29
  ds_write_b128 v154, v[16:19] offset:2048
  v_cvt_pk_bf16_f32 v23, v30, v31
  v_xor_b32 v24, 32, v154
  s_nop 0
  v_permlane32_swap_b32 v20, v22
  v_permlane32_swap_b32 v21, v23
  ds_write_b128 v24, v[20:23] offset:2048
  s_waitcnt lgkmcnt(9)
  v_mfma_f32_32x32x16_bf16 v[32:47], v[124:127], v[136:139], v[32:47]
  ds_read_b128 v[136:139], v148 offset:45056
  ds_write_b8 v153, v155 offset:4
  s_waitcnt lgkmcnt(8)
  v_mfma_f32_32x32x16_bf16 v[48:63], v[112:115], v[140:143], v[48:63]
  ds_read_b128 v[140:143], v149 offset:45056
  s_waitcnt lgkmcnt(7)
  v_mfma_f32_32x32x16_bf16 v[48:63], v[116:119], v[144:147], v[48:63]
  ds_read_b128 v[144:147], v150 offset:45056
  v_cvt_pk_bf16_f32 v32, v32, v33
  v_cvt_pk_bf16_f32 v33, v34, v35
  v_cvt_pk_bf16_f32 v34, v36, v37
  v_cvt_pk_bf16_f32 v35, v38, v39
  v_cvt_pk_bf16_f32 v36, v40, v41
  v_cvt_pk_bf16_f32 v37, v42, v43
  v_permlane32_swap_b32 v32, v34
  v_permlane32_swap_b32 v33, v35
  s_waitcnt lgkmcnt(7)
  v_mfma_f32_32x32x16_bf16 v[48:63], v[120:123], v[128:131], v[48:63]
  ds_read_b128 v[128:131], v151 offset:45056
  v_cvt_pk_bf16_f32 v38, v44, v45
  ds_write_b128 v154, v[32:35] offset:16640
  v_cvt_pk_bf16_f32 v39, v46, v47
  v_xor_b32 v40, 32, v154
  s_nop 0
  v_permlane32_swap_b32 v36, v38
  v_permlane32_swap_b32 v37, v39
  ds_write_b128 v40, v[36:39] offset:16640
  s_waitcnt lgkmcnt(9)
  v_mfma_f32_32x32x16_bf16 v[48:63], v[124:127], v[132:135], v[48:63]
  ds_read_b128 v[132:135], v148 offset:49152
  ds_write_b8 v153, v155 offset:8
  s_waitcnt lgkmcnt(8)
  v_mfma_f32_32x32x16_bf16 v[64:79], v[112:115], v[136:139], v[64:79]
  ds_read_b128 v[136:139], v149 offset:49152
  s_waitcnt lgkmcnt(7)
  v_mfma_f32_32x32x16_bf16 v[64:79], v[116:119], v[140:143], v[64:79]
  ds_read_b128 v[140:143], v150 offset:49152
  v_cvt_pk_bf16_f32 v48, v48, v49
  v_cvt_pk_bf16_f32 v49, v50, v51
  v_cvt_pk_bf16_f32 v50, v52, v53
  v_cvt_pk_bf16_f32 v51, v54, v55
  v_cvt_pk_bf16_f32 v52, v56, v57
  v_cvt_pk_bf16_f32 v53, v58, v59
  v_permlane32_swap_b32 v48, v50
  v_permlane32_swap_b32 v49, v51
  s_waitcnt lgkmcnt(7)
  v_mfma_f32_32x32x16_bf16 v[64:79], v[120:123], v[144:147], v[64:79]
  ds_read_b128 v[144:147], v151 offset:49152
  v_cvt_pk_bf16_f32 v54, v60, v61
  ds_write_b128 v154, v[48:51] offset:18688
  v_cvt_pk_bf16_f32 v55, v62, v63
  v_xor_b32 v56, 32, v154
  s_nop 0
  v_permlane32_swap_b32 v52, v54
  v_permlane32_swap_b32 v53, v55
  ds_write_b128 v56, v[52:55] offset:18688
  s_waitcnt lgkmcnt(9)
  v_mfma_f32_32x32x16_bf16 v[64:79], v[124:127], v[128:131], v[64:79]
  ds_write_b8 v153, v155 offset:12
  s_waitcnt lgkmcnt(7)
  v_mfma_f32_32x32x16_bf16 v[80:95], v[112:115], v[132:135], v[80:95]
  s_waitcnt lgkmcnt(5)
  v_mfma_f32_32x32x16_bf16 v[80:95], v[116:119], v[136:139], v[80:95]
  v_cvt_pk_bf16_f32 v64, v64, v65
  v_subrev_u32 v154, 126976, v154
  v_cvt_pk_bf16_f32 v65, v66, v67
  v_cvt_pk_bf16_f32 v66, v68, v69
  v_cvt_pk_bf16_f32 v67, v70, v71
  v_cvt_pk_bf16_f32 v68, v72, v73
  v_cvt_pk_bf16_f32 v69, v74, v75
  v_permlane32_swap_b32 v64, v66
  v_permlane32_swap_b32 v65, v67
  s_waitcnt lgkmcnt(4)
  v_mfma_f32_32x32x16_bf16 v[80:95], v[120:123], v[140:143], v[80:95]
  v_cvt_pk_bf16_f32 v70, v76, v77
  ds_write_b128 v154, v[64:67] offset:0
  v_cvt_pk_bf16_f32 v71, v78, v79
  v_xor_b32 v72, 32, v154
  s_nop 0
  v_permlane32_swap_b32 v68, v70
  v_permlane32_swap_b32 v69, v71
  ds_write_b128 v72, v[68:71] offset:0
  s_waitcnt lgkmcnt(5)
  v_mfma_f32_32x32x16_bf16 v[80:95], v[124:127], v[144:147], v[80:95]
  ds_write_b8 v153, v155 offset:16
  s_nop 10
  v_cvt_pk_bf16_f32 v80, v80, v81
  v_cvt_pk_bf16_f32 v81, v82, v83
  v_cvt_pk_bf16_f32 v82, v84, v85
  v_cvt_pk_bf16_f32 v83, v86, v87
  v_cvt_pk_bf16_f32 v84, v88, v89
  v_cvt_pk_bf16_f32 v85, v90, v91
  v_permlane32_swap_b32 v80, v82
  v_permlane32_swap_b32 v81, v83
  v_cvt_pk_bf16_f32 v86, v92, v93
  ds_write_b128 v154, v[80:83] offset:2048
  v_cvt_pk_bf16_f32 v87, v94, v95
  v_xor_b32 v88, 32, v154
  s_nop 0
  v_permlane32_swap_b32 v84, v86
  v_permlane32_swap_b32 v85, v87
  ds_write_b128 v88, v[84:87] offset:2048
  ds_write_b8 v153, v155 offset:20
  s_endpgm
L_a5:
  s_movk_i32 s57, 640
  s_mov_b32 s58, 0
  s_add_u32 s41, s40, 128
  s_cmp_eq_u32 s41, s57
  s_cselect_b32 s41, s58, s41
  s_add_u32 s42, s41, 128
  s_cmp_eq_u32 s42, s57
  s_cselect_b32 s42, s58, s42
  s_add_u32 s43, s42, 128
  s_cmp_eq_u32 s43, s57
  s_cselect_b32 s43, s58, s43
  s_add_u32 s44, s43, 128
  s_cmp_eq_u32 s44, s57
  s_cselect_b32 s44, s58, s44
  s_add_u32 s45, s40, 640
  s_add_u32 s46, s41, 640
  s_add_u32 s47, s42, 640
  s_add_u32 s48, s43, 640
  s_add_u32 s49, s44, 640
  s_mul_i32 s56, s42, 640
  s_add_u32 s81, s56, s59
  s_mul_i32 s56, s44, 640
  s_add_u32 s82, s56, s59
  s_mul_i32 s56, s46, 640
  s_add_u32 s83, s56, s59
  s_mul_i32 s56, s48, 640
  s_add_u32 s84, s56, s59
  s_mov_b32 s38, 0x7fff7fff
  s_mov_b32 s16, s4
  s_and_b32 s17, s5, 0xffff
  s_mov_b32 s18, 10485760
  s_mov_b32 s19, 0x20000
  v_lshrrev_b32 v12, 3, v6
  s_lshl_b32 s56, s39, 3
  v_add_u32 v12, s56, v12
  v_lshrrev_b32 v13, 1, v12
  v_xor_b32 v13, v13, v6
  v_and_b32 v13, 7, v13
  v_mul_u32_u24 v12, 1280, v12
  v_lshl_add_u32 v7, v13, 4, v12
  s_lshl_b32 s37, s39, 10
  s_mul_i32 s50, s36, 40960
  s_add_u32 s50, s50, s34
  s_add_u32 s57, s34, 204800
  s_add_u32 s51, s50, 40960
  s_cmp_eq_u32 s51, s57
  s_cselect_b32 s51, s34, s51
  s_add_u32 s52, s51, 40960
  s_cmp_eq_u32 s52, s57
  s_cselect_b32 s52, s34, s52
  s_add_u32 s53, s52, 40960
  s_cmp_eq_u32 s53, s57
  s_cselect_b32 s53, s34, s53
  s_add_u32 s54, s53, 40960
  s_cmp_eq_u32 s54, s57
  s_cselect_b32 s54, s34, s54
  s_add_u32 s90, s50, s59
  s_add_u32 s91, s51, s59
  s_add_u32 s92, s52, s59
  s_add_u32 s93, s53, s59
  s_add_u32 s94, s54, s59
  s_mov_b32 s24, s10
  s_and_b32 s25, s11, 0xffff
  s_mov_b32 s26, 10485760
  s_mov_b32 s27, 0x20000
  v_lshrrev_b32 v9, 2, v25
  v_mul_u32_u24 v9, 4160, v9
  v_lshl_add_u32 v14, v24, 8, v9
  v_and_b32 v12, 3, v25
  v_lshl_add_u32 v14, v12, 4, v14
  v_add_u32 v2, 126976, v14
  v_lshrrev_b32 v13, 4, v6
  s_lshl_b32 s56, s39, 3
  v_add_u32 v13, s56, v13
  v_lshrrev_b32 v14, 1, v13
  v_xor_b32 v14, v14, v12
  v_and_b32 v14, 3, v14
  v_lshlrev_b32 v14, 4, v14
  v_lshl_add_u32 v14, v13, 6, v14
  v_add_u32 v14, v14, v9
  v_add_u32 v3, 126976, v14
  v_mul_u32_u24 v13, 1280, v13
  v_lshl_add_u32 v4, v25, 4, v13
  v_lshlrev_b32 v26, 3, v6
  v_add_u32 v26, 160256, v26
  v_mov_b32 v5, 160768
  s_mov_b32 s3, 0x01010101
  s_waitcnt vmcnt(1)
  buffer_load_dwordx4 v[48:51], v1, s[20:23], s81 offen offset:0
  v_and_b32 v8, s38, v32
  v_and_b32 v16, s38, v33
  v_and_b32 v9, s38, v36
  v_and_b32 v17, s38, v37
  v_and_b32 v10, s38, v40
  v_and_b32 v18, s38, v41
  v_and_b32 v11, s38, v44
  v_and_b32 v19, s38, v45
  v_pk_max_u16 v12, v8, v9
  v_pk_max_u16 v20, v16, v17
  v_pk_min_u16 v13, v8, v9
  v_pk_min_u16 v21, v16, v17
  v_pk_max_u16 v14, v10, v11
  v_pk_max_u16 v22, v18, v19
  v_pk_min_u16 v15, v10, v11
  v_pk_min_u16 v23, v18, v19
  v_pk_min_u16 v12, v12, v14
  v_pk_min_u16 v20, v20, v22
  v_pk_max_u16 v13, v13, v15
  v_pk_max_u16 v21, v21, v23
  v_pk_max_u16 v12, v12, v13
  v_pk_max_u16 v20, v20, v21
  v_pk_sub_i16 v8, v8, v12
  buffer_load_dwordx4 v[52:55], v1, s[20:23], s81 offen offset:1280
  v_pk_sub_i16 v16, v16, v20
  v_pk_sub_i16 v9, v9, v12
  v_pk_sub_i16 v17, v17, v20
  v_pk_sub_i16 v10, v10, v12
  v_pk_sub_i16 v18, v18, v20
  v_pk_sub_i16 v11, v11, v12
  v_pk_sub_i16 v19, v19, v20
  v_pk_ashrrev_i16 v8, 15, v8 op_sel_hi:[0,1]
  v_pk_ashrrev_i16 v16, 15, v16 op_sel_hi:[0,1]
  v_pk_ashrrev_i16 v9, 15, v9 op_sel_hi:[0,1]
  v_pk_ashrrev_i16 v17, 15, v17 op_sel_hi:[0,1]
  v_pk_ashrrev_i16 v10, 15, v10 op_sel_hi:[0,1]
  v_pk_ashrrev_i16 v18, 15, v18 op_sel_hi:[0,1]
  v_pk_ashrrev_i16 v11, 15, v11 op_sel_hi:[0,1]
  v_pk_ashrrev_i16 v19, 15, v19 op_sel_hi:[0,1]
  v_bfi_b32 v32, v8, 0, v32
  v_bfi_b32 v33, v16, 0, v33
  v_bfi_b32 v36, v9, 0, v36
  v_bfi_b32 v37, v17, 0, v37
  v_bfi_b32 v40, v10, 0, v40
  v_bfi_b32 v41, v18, 0, v41
  v_bfi_b32 v44, v11, 0, v44
  v_bfi_b32 v45, v19, 0, v45
  buffer_load_dwordx4 v[56:59], v1, s[20:23], s81 offen offset:2560
  v_and_b32 v8, s38, v34
  v_and_b32 v16, s38, v35
  v_and_b32 v9, s38, v38
  v_and_b32 v17, s38, v39
  v_and_b32 v10, s38, v42
  v_and_b32 v18, s38, v43
  v_and_b32 v11, s38, v46
  v_and_b32 v19, s38, v47
  v_pk_max_u16 v12, v8, v9
  v_pk_max_u16 v20, v16, v17
  v_pk_min_u16 v13, v8, v9
  v_pk_min_u16 v21, v16, v17
  v_pk_max_u16 v14, v10, v11
  v_pk_max_u16 v22, v18, v19
  v_pk_min_u16 v15, v10, v11
  v_pk_min_u16 v23, v18, v19
  v_pk_min_u16 v12, v12, v14
  v_pk_min_u16 v20, v20, v22
  v_pk_max_u16 v13, v13, v15
  v_pk_max_u16 v21, v21, v23
  v_pk_max_u16 v12, v12, v13
  v_pk_max_u16 v20, v20, v21
  v_pk_sub_i16 v8, v8, v12
  buffer_load_dwordx4 v[60:63], v1, s[20:23], s81 offen offset:3840
  v_pk_sub_i16 v16, v16, v20
  v_pk_sub_i16 v9, v9, v12
  v_pk_sub_i16 v17, v17, v20
  v_pk_sub_i16 v10, v10, v12
  v_pk_sub_i16 v18, v18, v20
  v_pk_sub_i16 v11, v11, v12
  v_pk_sub_i16 v19, v19, v20
  v_pk_ashrrev_i16 v8, 15, v8 op_sel_hi:[0,1]
  v_pk_ashrrev_i16 v16, 15, v16 op_sel_hi:[0,1]
  v_pk_ashrrev_i16 v9, 15, v9 op_sel_hi:[0,1]
  v_pk_ashrrev_i16 v17, 15, v17 op_sel_hi:[0,1]
  v_pk_ashrrev_i16 v10, 15, v10 op_sel_hi:[0,1]
  v_pk_ashrrev_i16 v18, 15, v18 op_sel_hi:[0,1]
  v_pk_ashrrev_i16 v11, 15, v11 op_sel_hi:[0,1]
  v_pk_ashrrev_i16 v19, 15, v19 op_sel_hi:[0,1]
  v_bfi_b32 v34, v8, 0, v34
  v_bfi_b32 v35, v16, 0, v35
  v_bfi_b32 v38, v9, 0, v38
  v_bfi_b32 v39, v17, 0, v39
  v_bfi_b32 v42, v10, 0, v42
  v_bfi_b32 v43, v18, 0, v43
  v_bfi_b32 v46, v11, 0, v46
  v_bfi_b32 v47, v19, 0, v47
  ds_write_b128 v2, v[32:35] offset:0
  ds_write_b128 v2, v[36:39] offset:64
  ds_write_b128 v2, v[40:43] offset:128
  ds_write_b128 v2, v[44:47] offset:192
  s_waitcnt vmcnt(4)
  v_lshlrev_b32 v28, 16, v27
  v_and_b32 v29, 0xffff0000, v27
  ds_write_b64 v26, v[28:29]
  s_setprio 0
  s_waitcnt lgkmcnt(0)
  s_barrier
  s_waitcnt vmcnt(0)
  buffer_load_dwordx4 v[32:35], v1, s[20:23], s82 offen offset:0
  v_and_b32 v8, s38, v48
  v_and_b32 v16, s38, v49
  v_and_b32 v9, s38, v52
  v_and_b32 v17, s38, v53
  v_and_b32 v10, s38, v56
  v_and_b32 v18, s38, v57
  v_and_b32 v11, s38, v60
  v_and_b32 v19, s38, v61
  v_pk_max_u16 v12, v8, v9
  v_pk_max_u16 v20, v16, v17
  v_pk_min_u16 v13, v8, v9
  v_pk_min_u16 v21, v16, v17
  v_pk_max_u16 v14, v10, v11
  v_pk_max_u16 v22, v18, v19
  v_pk_min_u16 v15, v10, v11
  v_pk_min_u16 v23, v18, v19
  v_pk_min_u16 v12, v12, v14
  v_pk_min_u16 v20, v20, v22
  v_pk_max_u16 v13, v13, v15
  v_pk_max_u16 v21, v21, v23
  buffer_load_dwordx4 v[36:39], v1, s[20:23], s82 offen offset:1280
  v_pk_max_u16 v12, v12, v13
  v_pk_max_u16 v20, v20, v21
  v_pk_sub_i16 v8, v8, v12
  v_pk_sub_i16 v16, v16, v20
  v_pk_sub_i16 v9, v9, v12
  v_pk_sub_i16 v17, v17, v20
  v_pk_sub_i16 v10, v10, v12
  v_pk_sub_i16 v18, v18, v20
  v_pk_sub_i16 v11, v11, v12
  v_pk_sub_i16 v19, v19, v20
  v_pk_ashrrev_i16 v8, 15, v8 op_sel_hi:[0,1]
  v_pk_ashrrev_i16 v16, 15, v16 op_sel_hi:[0,1]
  v_pk_ashrrev_i16 v9, 15, v9 op_sel_hi:[0,1]
  v_pk_ashrrev_i16 v17, 15, v17 op_sel_hi:[0,1]
  v_pk_ashrrev_i16 v10, 15, v10 op_sel_hi:[0,1]
  v_pk_ashrrev_i16 v18, 15, v18 op_sel_hi:[0,1]
  v_pk_ashrrev_i16 v11, 15, v11 op_sel_hi:[0,1]
  v_pk_ashrrev_i16 v19, 15, v19 op_sel_hi:[0,1]
  v_bfi_b32 v48, v8, 0, v48
  buffer_load_dwordx4 v[40:43], v1, s[20:23], s82 offen offset:2560
  v_bfi_b32 v49, v16, 0, v49
  v_bfi_b32 v52, v9, 0, v52
  v_bfi_b32 v53, v17, 0, v53
  v_bfi_b32 v56, v10, 0, v56
  v_bfi_b32 v57, v18, 0, v57
  v_bfi_b32 v60, v11, 0, v60
  v_bfi_b32 v61, v19, 0, v61
  v_and_b32 v8, s38, v50
  v_and_b32 v16, s38, v51
  v_and_b32 v9, s38, v54
  v_and_b32 v17, s38, v55
  v_and_b32 v10, s38, v58
  v_and_b32 v18, s38, v59
  v_and_b32 v11, s38, v62
  v_and_b32 v19, s38, v63
  v_pk_max_u16 v12, v8, v9
  v_pk_max_u16 v20, v16, v17
  v_pk_min_u16 v13, v8, v9
  v_pk_min_u16 v21, v16, v17
  v_pk_max_u16 v14, v10, v11
  buffer_load_dwordx4 v[44:47], v1, s[20:23], s82 offen offset:3840
  v_pk_max_u16 v22, v18, v19
  v_pk_min_u16 v15, v10, v11
  v_pk_min_u16 v23, v18, v19
  v_pk_min_u16 v12, v12, v14
  v_pk_min_u16 v20, v20, v22
  v_pk_max_u16 v13, v13, v15
  v_pk_max_u16 v21, v21, v23
  v_pk_max_u16 v12, v12, v13
  v_pk_max_u16 v20, v20, v21
  v_pk_sub_i16 v8, v8, v12
  v_pk_sub_i16 v16, v16, v20
  v_pk_sub_i16 v9, v9, v12
  v_pk_sub_i16 v17, v17, v20
  v_pk_sub_i16 v10, v10, v12
  v_pk_sub_i16 v18, v18, v20
  v_pk_sub_i16 v11, v11, v12
  v_pk_sub_i16 v19, v19, v20
  v_pk_ashrrev_i16 v8, 15, v8 op_sel_hi:[0,1]
  v_pk_ashrrev_i16 v16, 15, v16 op_sel_hi:[0,1]
  s_waitcnt lgkmcnt(0)
  s_barrier
  s_setprio 1
  v_pk_ashrrev_i16 v9, 15, v9 op_sel_hi:[0,1]
  v_pk_ashrrev_i16 v17, 15, v17 op_sel_hi:[0,1]
  v_pk_ashrrev_i16 v10, 15, v10 op_sel_hi:[0,1]
  v_pk_ashrrev_i16 v18, 15, v18 op_sel_hi:[0,1]
  v_pk_ashrrev_i16 v11, 15, v11 op_sel_hi:[0,1]
  v_pk_ashrrev_i16 v19, 15, v19 op_sel_hi:[0,1]
  v_bfi_b32 v50, v8, 0, v50
  v_bfi_b32 v51, v16, 0, v51
  v_bfi_b32 v54, v9, 0, v54
  v_bfi_b32 v55, v17, 0, v55
  v_bfi_b32 v58, v10, 0, v58
  v_bfi_b32 v59, v18, 0, v59
  v_bfi_b32 v62, v11, 0, v62
  v_bfi_b32 v63, v19, 0, v63
  ds_write_b128 v2, v[48:51] offset:0
  s_add_u32 m0, s37, 81920
  s_add_u32 s56, s50, s44
  buffer_load_dwordx4 v7, s[16:19], s56 offen  lds
  ds_write_b128 v2, v[52:55] offset:64
  s_add_u32 m0, s37, 86016
  s_add_u32 s56, s51, s44
  buffer_load_dwordx4 v7, s[16:19], s56 offen  lds
  ds_write_b128 v2, v[56:59] offset:128
  s_add_u32 m0, s37, 90112
  s_add_u32 s56, s52, s44
  buffer_load_dwordx4 v7, s[16:19], s56 offen  lds
  ds_write_b128 v2, v[60:63] offset:192
  s_add_u32 m0, s37, 94208
  s_add_u32 s56, s53, s44
  buffer_load_dwordx4 v7, s[16:19], s56 offen  lds
  s_setprio 0
  s_add_u32 m0, s37, 98304
  s_add_u32 s56, s54, s44
  buffer_load_dwordx4 v7, s[16:19], s56 offen  lds
  s_waitcnt lgkmcnt(0)
  s_barrier
  s_waitcnt vmcnt(5)
  buffer_load_dwordx4 v[48:51], v1, s[20:23], s83 offen offset:0
  v_and_b32 v8, s38, v32
  v_and_b32 v16, s38, v33
  v_and_b32 v9, s38, v36
  v_and_b32 v17, s38, v37
  v_and_b32 v10, s38, v40
  v_and_b32 v18, s38, v41
  v_and_b32 v11, s38, v44
  v_and_b32 v19, s38, v45
  v_pk_max_u16 v12, v8, v9
  v_pk_max_u16 v20, v16, v17
  v_pk_min_u16 v13, v8, v9
  v_pk_min_u16 v21, v16, v17
  v_pk_max_u16 v14, v10, v11
  v_pk_max_u16 v22, v18, v19
  v_pk_min_u16 v15, v10, v11
  v_pk_min_u16 v23, v18, v19
  v_pk_min_u16 v12, v12, v14
  v_pk_min_u16 v20, v20, v22
  v_pk_max_u16 v13, v13, v15
  v_pk_max_u16 v21, v21, v23
  buffer_load_dwordx4 v[52:55], v1, s[20:23], s83 offen offset:1280
  v_pk_max_u16 v12, v12, v13
  v_pk_max_u16 v20, v20, v21
  v_pk_sub_i16 v8, v8, v12
  v_pk_sub_i16 v16, v16, v20
  v_pk_sub_i16 v9, v9, v12
  v_pk_sub_i16 v17, v17, v20
  v_pk_sub_i16 v10, v10, v12
  v_pk_sub_i16 v18, v18, v20
  v_pk_sub_i16 v11, v11, v12
  v_pk_sub_i16 v19, v19, v20
  v_pk_ashrrev_i16 v8, 15, v8 op_sel_hi:[0,1]
  v_pk_ashrrev_i16 v16, 15, v16 op_sel_hi:[0,1]
  v_pk_ashrrev_i16 v9, 15, v9 op_sel_hi:[0,1]
  v_pk_ashrrev_i16 v17, 15, v17 op_sel_hi:[0,1]
  v_pk_ashrrev_i16 v10, 15, v10 op_sel_hi:[0,1]
  v_pk_ashrrev_i16 v18, 15, v18 op_sel_hi:[0,1]
  v_pk_ashrrev_i16 v11, 15, v11 op_sel_hi:[0,1]
  v_pk_ashrrev_i16 v19, 15, v19 op_sel_hi:[0,1]
  v_bfi_b32 v32, v8, 0, v32
  buffer_load_dwordx4 v[56:59], v1, s[20:23], s83 offen offset:2560
  v_bfi_b32 v33, v16, 0, v33
  v_bfi_b32 v36, v9, 0, v36
  v_bfi_b32 v37, v17, 0, v37
  v_bfi_b32 v40, v10, 0, v40
  v_bfi_b32 v41, v18, 0, v41
  v_bfi_b32 v44, v11, 0, v44
  v_bfi_b32 v45, v19, 0, v45
  v_and_b32 v8, s38, v34
  v_and_b32 v16, s38, v35
  v_and_b32 v9, s38, v38
  v_and_b32 v17, s38, v39
  v_and_b32 v10, s38, v42
  v_and_b32 v18, s38, v43
  v_and_b32 v11, s38, v46
  v_and_b32 v19, s38, v47
  v_pk_max_u16 v12, v8, v9
  v_pk_max_u16 v20, v16, v17
  v_pk_min_u16 v13, v8, v9
  v_pk_min_u16 v21, v16, v17
  v_pk_max_u16 v14, v10, v11
  buffer_load_dwordx4 v[60:63], v1, s[20:23], s83 offen offset:3840
  v_pk_max_u16 v22, v18, v19
  v_pk_min_u16 v15, v10, v11
  v_pk_min_u16 v23, v18, v19
  v_pk_min_u16 v12, v12, v14
  v_pk_min_u16 v20, v20, v22
  v_pk_max_u16 v13, v13, v15
  v_pk_max_u16 v21, v21, v23
  v_pk_max_u16 v12, v12, v13
  v_pk_max_u16 v20, v20, v21
  v_pk_sub_i16 v8, v8, v12
  v_pk_sub_i16 v16, v16, v20
  v_pk_sub_i16 v9, v9, v12
  v_pk_sub_i16 v17, v17, v20
  v_pk_sub_i16 v10, v10, v12
  v_pk_sub_i16 v18, v18, v20
  v_pk_sub_i16 v11, v11, v12
  v_pk_sub_i16 v19, v19, v20
  v_pk_ashrrev_i16 v8, 15, v8 op_sel_hi:[0,1]
  v_pk_ashrrev_i16 v16, 15, v16 op_sel_hi:[0,1]
  s_waitcnt lgkmcnt(0)
  s_barrier
  s_setprio 1
  v_pk_ashrrev_i16 v9, 15, v9 op_sel_hi:[0,1]
  v_pk_ashrrev_i16 v17, 15, v17 op_sel_hi:[0,1]
  v_pk_ashrrev_i16 v10, 15, v10 op_sel_hi:[0,1]
  v_pk_ashrrev_i16 v18, 15, v18 op_sel_hi:[0,1]
  v_pk_ashrrev_i16 v11, 15, v11 op_sel_hi:[0,1]
  v_pk_ashrrev_i16 v19, 15, v19 op_sel_hi:[0,1]
  v_bfi_b32 v34, v8, 0, v34
  v_bfi_b32 v35, v16, 0, v35
  v_bfi_b32 v38, v9, 0, v38
  v_bfi_b32 v39, v17, 0, v39
  v_bfi_b32 v42, v10, 0, v42
  v_bfi_b32 v43, v18, 0, v43
  v_bfi_b32 v46, v11, 0, v46
  v_bfi_b32 v47, v19, 0, v47
  ds_write_b128 v2, v[32:35] offset:0
  s_add_u32 m0, s37, 122880
  s_add_u32 s56, s50, s46
  buffer_load_dwordx4 v7, s[16:19], s56 offen  lds
  ds_write_b128 v2, v[36:39] offset:64
  s_add_u32 m0, s37, 0
  s_add_u32 s56, s51, s46
  buffer_load_dwordx4 v7, s[16:19], s56 offen  lds
  ds_write_b128 v2, v[40:43] offset:128
  s_add_u32 m0, s37, 4096
  s_add_u32 s56, s52, s46
  buffer_load_dwordx4 v7, s[16:19], s56 offen  lds
  ds_write_b128 v2, v[44:47] offset:192
  s_add_u32 m0, s37, 8192
  s_add_u32 s56, s53, s46
  buffer_load_dwordx4 v7, s[16:19], s56 offen  lds
  s_setprio 0
  s_add_u32 m0, s37, 12288
  s_add_u32 s56, s54, s46
  buffer_load_dwordx4 v7, s[16:19], s56 offen  lds
  s_waitcnt vmcnt(9)
  s_waitcnt lgkmcnt(0)
  s_barrier
  s_waitcnt vmcnt(5)
  buffer_load_dwordx4 v[32:35], v1, s[20:23], s84 offen offset:0
  v_and_b32 v8, s38, v48
  v_and_b32 v16, s38, v49
  v_and_b32 v9, s38, v52
  v_and_b32 v17, s38, v53
  v_and_b32 v10, s38, v56
  v_and_b32 v18, s38, v57
  v_and_b32 v11, s38, v60
  v_and_b32 v19, s38, v61
  v_pk_max_u16 v12, v8, v9
  v_pk_max_u16 v20, v16, v17
  v_pk_min_u16 v13, v8, v9
  v_pk_min_u16 v21, v16, v17
  v_pk_max_u16 v14, v10, v11
  v_pk_max_u16 v22, v18, v19
  v_pk_min_u16 v15, v10, v11
  v_pk_min_u16 v23, v18, v19
  v_pk_min_u16 v12, v12, v14
  v_pk_min_u16 v20, v20, v22
  v_pk_max_u16 v13, v13, v15
  v_pk_max_u16 v21, v21, v23
  buffer_load_dwordx4 v[36:39], v1, s[20:23], s84 offen offset:1280
  v_pk_max_u16 v12, v12, v13
  v_pk_max_u16 v20, v20, v21
  v_pk_sub_i16 v8, v8, v12
  v_pk_sub_i16 v16, v16, v20
  v_pk_sub_i16 v9, v9, v12
  v_pk_sub_i16 v17, v17, v20
  v_pk_sub_i16 v10, v10, v12
  v_pk_sub_i16 v18, v18, v20
  v_pk_sub_i16 v11, v11, v12
  v_pk_sub_i16 v19, v19, v20
  v_pk_ashrrev_i16 v8, 15, v8 op_sel_hi:[0,1]
  v_pk_ashrrev_i16 v16, 15, v16 op_sel_hi:[0,1]
  v_pk_ashrrev_i16 v9, 15, v9 op_sel_hi:[0,1]
  v_pk_ashrrev_i16 v17, 15, v17 op_sel_hi:[0,1]
  v_pk_ashrrev_i16 v10, 15, v10 op_sel_hi:[0,1]
  v_pk_ashrrev_i16 v18, 15, v18 op_sel_hi:[0,1]
  v_pk_ashrrev_i16 v11, 15, v11 op_sel_hi:[0,1]
  v_pk_ashrrev_i16 v19, 15, v19 op_sel_hi:[0,1]
  v_bfi_b32 v48, v8, 0, v48
  buffer_load_dwordx4 v[40:43], v1, s[20:23], s84 offen offset:2560
  v_bfi_b32 v49, v16, 0, v49
  v_bfi_b32 v52, v9, 0, v52
  v_bfi_b32 v53, v17, 0, v53
  v_bfi_b32 v56, v10, 0, v56
  v_bfi_b32 v57, v18, 0, v57
  v_bfi_b32 v60, v11, 0, v60
  v_bfi_b32 v61, v19, 0, v61
  v_and_b32 v8, s38, v50
  v_and_b32 v16, s38, v51
  v_and_b32 v9, s38, v54
  v_and_b32 v17, s38, v55
  v_and_b32 v10, s38, v58
  v_and_b32 v18, s38, v59
  v_and_b32 v11, s38, v62
  v_and_b32 v19, s38, v63
  v_pk_max_u16 v12, v8, v9
  v_pk_max_u16 v20, v16, v17
  v_pk_min_u16 v13, v8, v9
  v_pk_min_u16 v21, v16, v17
  v_pk_max_u16 v14, v10, v11
  buffer_load_dwordx4 v[44:47], v1, s[20:23], s84 offen offset:3840
  v_pk_max_u16 v22, v18, v19
  v_pk_min_u16 v15, v10, v11
  v_pk_min_u16 v23, v18, v19
  v_pk_min_u16 v12, v12, v14
  v_pk_min_u16 v20, v20, v22
  v_pk_max_u16 v13, v13, v15
  v_pk_max_u16 v21, v21, v23
  v_pk_max_u16 v12, v12, v13
  v_pk_max_u16 v20, v20, v21
  v_pk_sub_i16 v8, v8, v12
  v_pk_sub_i16 v16, v16, v20
  v_pk_sub_i16 v9, v9, v12
  v_pk_sub_i16 v17, v17, v20
  v_pk_sub_i16 v10, v10, v12
  v_pk_sub_i16 v18, v18, v20
  v_pk_sub_i16 v11, v11, v12
  v_pk_sub_i16 v19, v19, v20
  v_pk_ashrrev_i16 v8, 15, v8 op_sel_hi:[0,1]
  v_pk_ashrrev_i16 v16, 15, v16 op_sel_hi:[0,1]
  s_waitcnt lgkmcnt(0)
  s_barrier
  s_setprio 1
  v_pk_ashrrev_i16 v9, 15, v9 op_sel_hi:[0,1]
  v_pk_ashrrev_i16 v17, 15, v17 op_sel_hi:[0,1]
  v_pk_ashrrev_i16 v10, 15, v10 op_sel_hi:[0,1]
  v_pk_ashrrev_i16 v18, 15, v18 op_sel_hi:[0,1]
  v_pk_ashrrev_i16 v11, 15, v11 op_sel_hi:[0,1]
  v_pk_ashrrev_i16 v19, 15, v19 op_sel_hi:[0,1]
  v_bfi_b32 v50, v8, 0, v50
  v_bfi_b32 v51, v16, 0, v51
  v_bfi_b32 v54, v9, 0, v54
  v_bfi_b32 v55, v17, 0, v55
  v_bfi_b32 v58, v10, 0, v58
  v_bfi_b32 v59, v18, 0, v59
  v_bfi_b32 v62, v11, 0, v62
  v_bfi_b32 v63, v19, 0, v63
  ds_write_b128 v2, v[48:51] offset:0
  s_add_u32 m0, s37, 36864
  s_add_u32 s56, s50, s48
  buffer_load_dwordx4 v7, s[16:19], s56 offen  lds
  ds_write_b128 v2, v[52:55] offset:64
  s_add_u32 m0, s37, 40960
  s_add_u32 s56, s51, s48
  buffer_load_dwordx4 v7, s[16:19], s56 offen  lds
  ds_write_b128 v2, v[56:59] offset:128
  s_add_u32 m0, s37, 45056
  s_add_u32 s56, s52, s48
  buffer_load_dwordx4 v7, s[16:19], s56 offen  lds
  ds_write_b128 v2, v[60:63] offset:192
  s_add_u32 m0, s37, 49152
  s_add_u32 s56, s53, s48
  buffer_load_dwordx4 v7, s[16:19], s56 offen  lds
  s_setprio 0
  s_add_u32 m0, s37, 53248
  s_add_u32 s56, s54, s48
  buffer_load_dwordx4 v7, s[16:19], s56 offen  lds
  s_waitcnt vmcnt(9)
  s_waitcnt lgkmcnt(0)
  s_barrier
  s_waitcnt vmcnt(5)
  v_and_b32 v8, s38, v32
  v_and_b32 v16, s38, v33
  v_and_b32 v9, s38, v36
  v_and_b32 v17, s38, v37
  v_and_b32 v10, s38, v40
  v_and_b32 v18, s38, v41
  v_and_b32 v11, s38, v44
  v_and_b32 v19, s38, v45
  v_pk_max_u16 v12, v8, v9
  v_pk_max_u16 v20, v16, v17
  v_pk_min_u16 v13, v8, v9
  v_pk_min_u16 v21, v16, v17
  v_pk_max_u16 v14, v10, v11
  v_pk_max_u16 v22, v18, v19
  v_pk_min_u16 v15, v10, v11
  v_pk_min_u16 v23, v18, v19
  v_pk_min_u16 v12, v12, v14
  v_pk_min_u16 v20, v20, v22
  v_pk_max_u16 v13, v13, v15
  v_pk_max_u16 v21, v21, v23
  v_pk_max_u16 v12, v12, v13
  v_pk_max_u16 v20, v20, v21
  v_pk_sub_i16 v8, v8, v12
  v_pk_sub_i16 v16, v16, v20
  v_pk_sub_i16 v9, v9, v12
  v_pk_sub_i16 v17, v17, v20
  v_pk_sub_i16 v10, v10, v12
  v_pk_sub_i16 v18, v18, v20
  v_pk_sub_i16 v11, v11, v12
  v_pk_sub_i16 v19, v19, v20
  v_pk_ashrrev_i16 v8, 15, v8 op_sel_hi:[0,1]
  v_pk_ashrrev_i16 v16, 15, v16 op_sel_hi:[0,1]
  v_pk_ashrrev_i16 v9, 15, v9 op_sel_hi:[0,1]
  v_pk_ashrrev_i16 v17, 15, v17 op_sel_hi:[0,1]
  v_pk_ashrrev_i16 v10, 15, v10 op_sel_hi:[0,1]
  v_pk_ashrrev_i16 v18, 15, v18 op_sel_hi:[0,1]
  v_pk_ashrrev_i16 v11, 15, v11 op_sel_hi:[0,1]
  v_pk_ashrrev_i16 v19, 15, v19 op_sel_hi:[0,1]
  v_bfi_b32 v32, v8, 0, v32
  v_bfi_b32 v33, v16, 0, v33
  v_bfi_b32 v36, v9, 0, v36
  v_bfi_b32 v37, v17, 0, v37
  v_bfi_b32 v40, v10, 0, v40
  v_bfi_b32 v41, v18, 0, v41
  v_bfi_b32 v44, v11, 0, v44
  v_bfi_b32 v45, v19, 0, v45
  v_and_b32 v8, s38, v34
  v_and_b32 v16, s38, v35
  v_and_b32 v9, s38, v38
  v_and_b32 v17, s38, v39
  v_and_b32 v10, s38, v42
  v_and_b32 v18, s38, v43
  v_and_b32 v11, s38, v46
  v_and_b32 v19, s38, v47
  v_pk_max_u16 v12, v8, v9
  v_pk_max_u16 v20, v16, v17
  v_pk_min_u16 v13, v8, v9
  v_pk_min_u16 v21, v16, v17
  v_pk_max_u16 v14, v10, v11
  v_pk_max_u16 v22, v18, v19
  v_pk_min_u16 v15, v10, v11
  v_pk_min_u16 v23, v18, v19
  v_pk_min_u16 v12, v12, v14
  v_pk_min_u16 v20, v20, v22
  v_pk_max_u16 v13, v13, v15
  v_pk_max_u16 v21, v21, v23
  v_pk_max_u16 v12, v12, v13
  v_pk_max_u16 v20, v20, v21
  v_pk_sub_i16 v8, v8, v12
  v_pk_sub_i16 v16, v16, v20
  v_pk_sub_i16 v9, v9, v12
  v_pk_sub_i16 v17, v17, v20
  v_pk_sub_i16 v10, v10, v12
  v_pk_sub_i16 v18, v18, v20
  v_pk_sub_i16 v11, v11, v12
  v_pk_sub_i16 v19, v19, v20
  v_pk_ashrrev_i16 v8, 15, v8 op_sel_hi:[0,1]
  v_pk_ashrrev_i16 v16, 15, v16 op_sel_hi:[0,1]
  s_waitcnt lgkmcnt(0)
  s_barrier
  s_setprio 1
  v_pk_ashrrev_i16 v9, 15, v9 op_sel_hi:[0,1]
  v_pk_ashrrev_i16 v17, 15, v17 op_sel_hi:[0,1]
  v_pk_ashrrev_i16 v10, 15, v10 op_sel_hi:[0,1]
  v_pk_ashrrev_i16 v18, 15, v18 op_sel_hi:[0,1]
  v_pk_ashrrev_i16 v11, 15, v11 op_sel_hi:[0,1]
  v_pk_ashrrev_i16 v19, 15, v19 op_sel_hi:[0,1]
  v_bfi_b32 v34, v8, 0, v34
  v_bfi_b32 v35, v16, 0, v35
  v_bfi_b32 v38, v9, 0, v38
  v_bfi_b32 v39, v17, 0, v39
  v_bfi_b32 v42, v10, 0, v42
  v_bfi_b32 v43, v18, 0, v43
  v_bfi_b32 v46, v11, 0, v46
  v_bfi_b32 v47, v19, 0, v47
  ds_write_b128 v2, v[32:35] offset:0
  ds_write_b128 v2, v[36:39] offset:64
  ds_write_b128 v2, v[40:43] offset:128
  ds_write_b128 v2, v[44:47] offset:192
  s_setprio 0
  s_waitcnt vmcnt(0)
  s_waitcnt lgkmcnt(0)
  s_barrier
  s_waitcnt lgkmcnt(0)
  s_barrier
  v_subrev_u32 v29, 126976, v3
L_poll5_0_0:
  ds_read_b32 v28, v5 offset:0
  ds_read_b128 v[64:67], v3 offset:0
  s_waitcnt lgkmcnt(0)
  v_cmp_ne_u32 vcc, s3, v28
  s_cbranch_vccnz L_poll5_0_0
  buffer_store_dwordx4 v[64:67], v4, s[24:27], s90 offen sc1
L_poll5_0_1:
  ds_read_b32 v28, v5 offset:4
  ds_read_b128 v[68:71], v3 offset:2048
  s_waitcnt lgkmcnt(0)
  v_cmp_ne_u32 vcc, s3, v28
  s_cbranch_vccnz L_poll5_0_1
  buffer_store_dwordx4 v[68:71], v4, s[24:27], s91 offen sc1
L_poll5_0_2:
  ds_read_b32 v28, v5 offset:8
  ds_read_b128 v[72:75], v3 offset:16640
  s_waitcnt lgkmcnt(0)
  v_cmp_ne_u32 vcc, s3, v28
  s_cbranch_vccnz L_poll5_0_2
  buffer_store_dwordx4 v[72:75], v4, s[24:27], s92 offen sc1
L_poll5_0_3:
  ds_read_b32 v28, v5 offset:12
  ds_read_b128 v[76:79], v3 offset:18688
  s_waitcnt lgkmcnt(0)
  v_cmp_ne_u32 vcc, s3, v28
  s_cbranch_vccnz L_poll5_0_3
  buffer_store_dwordx4 v[76:79], v4, s[24:27], s93 offen sc1
L_poll5_0_4:
  ds_read_b32 v28, v5 offset:16
  ds_read_b128 v[80:83], v29 offset:0
  s_waitcnt lgkmcnt(0)
  v_cmp_ne_u32 vcc, s3, v28
  s_cbranch_vccnz L_poll5_0_4
  buffer_store_dwordx4 v[80:83], v4, s[24:27], s94 offen sc1
  s_endpgm
L_b5:
  s_movk_i32 s57, 640
  s_mov_b32 s58, 0
  s_add_u32 s42, s41, 128
  s_cmp_eq_u32 s42, s57
  s_cselect_b32 s42, s58, s42
  s_add_u32 s43, s42, 128
  s_cmp_eq_u32 s43, s57
  s_cselect_b32 s43, s58, s43
  s_add_u32 s44, s43, 128
  s_cmp_eq_u32 s44, s57
  s_cselect_b32 s44, s58, s44
  s_add_u32 s45, s40, 640
  s_add_u32 s46, s41, 640
  s_add_u32 s47, s42, 640
  s_add_u32 s48, s43, 640
  s_add_u32 s49, s44, 640
  s_mul_i32 s56, s43, 640
  s_add_u32 s81, s56, s59
  s_mul_i32 s56, s45, 640
  s_add_u32 s82, s56, s59
  s_mul_i32 s56, s47, 640
  s_add_u32 s83, s56, s59
  s_mul_i32 s56, s49, 640
  s_add_u32 s84, s56, s59
  s_mov_b32 s38, 0x7fff7fff
  s_mov_b32 s16, s4
  s_and_b32 s17, s5, 0xffff
  s_mov_b32 s18, 10485760
  s_mov_b32 s19, 0x20000
  v_lshrrev_b32 v12, 3, v6
  s_lshl_b32 s56, s39, 3
  v_add_u32 v12, s56, v12
  v_lshrrev_b32 v13, 1, v12
  v_xor_b32 v13, v13, v6
  v_and_b32 v13, 7, v13
  v_mul_u32_u24 v12, 1280, v12
  v_lshl_add_u32 v7, v13, 4, v12
  s_lshl_b32 s37, s39, 10
  s_mul_i32 s50, s36, 40960
  s_add_u32 s50, s50, s34
  s_add_u32 s57, s34, 204800
  s_add_u32 s51, s50, 40960
  s_cmp_eq_u32 s51, s57
  s_cselect_b32 s51, s34, s51
  s_add_u32 s52, s51, 40960
  s_cmp_eq_u32 s52, s57
  s_cselect_b32 s52, s34, s52
  s_add_u32 s53, s52, 40960
  s_cmp_eq_u32 s53, s57
  s_cselect_b32 s53, s34, s53
  s_add_u32 s54, s53, 40960
  s_cmp_eq_u32 s54, s57
  s_cselect_b32 s54, s34, s54
  s_add_u32 s90, s50, s59
  s_add_u32 s91, s51, s59
  s_add_u32 s92, s52, s59
  s_add_u32 s93, s53, s59
  s_add_u32 s94, s54, s59
  s_mov_b32 s24, s10
  s_and_b32 s25, s11, 0xffff
  s_mov_b32 s26, 10485760
  s_mov_b32 s27, 0x20000
  v_lshrrev_b32 v9, 2, v25
  v_mul_u32_u24 v9, 4160, v9
  v_lshl_add_u32 v14, v24, 8, v9
  v_and_b32 v12, 3, v25
  v_lshl_add_u32 v14, v12, 4, v14
  v_add_u32 v2, 126976, v14
  v_lshrrev_b32 v13, 4, v6
  s_lshl_b32 s56, s39, 3
  s_add_u32 s56, s56, 4
  v_add_u32 v13, s56, v13
  v_lshrrev_b32 v14, 1, v13
  v_xor_b32 v14, v14, v12
  v_and_b32 v14, 3, v14
  v_lshlrev_b32 v14, 4, v14
  v_lshl_add_u32 v14, v13, 6, v14
  v_add_u32 v14, v14, v9
  v_add_u32 v3, 126976, v14
  v_mul_u32_u24 v13, 1280, v13
  v_lshl_add_u32 v4, v25, 4, v13
  v_mov_b32 v5, 160768
  s_mov_b32 s3, 0x01010101
  v_lshl_add_u32 v28, v6, 2, v5
  v_mov_b32 v29, 0
  ds_write_b32 v28, v29
  s_waitcnt vmcnt(0)
  buffer_load_dwordx4 v[48:51], v1, s[20:23], s81 offen offset:0
  v_and_b32 v8, s38, v32
  v_and_b32 v16, s38, v33
  v_and_b32 v9, s38, v36
  v_and_b32 v17, s38, v37
  v_and_b32 v10, s38, v40
  v_and_b32 v18, s38, v41
  v_and_b32 v11, s38, v44
  v_and_b32 v19, s38, v45
  v_pk_max_u16 v12, v8, v9
  v_pk_max_u16 v20, v16, v17
  v_pk_min_u16 v13, v8, v9
  v_pk_min_u16 v21, v16, v17
  v_pk_max_u16 v14, v10, v11
  v_pk_max_u16 v22, v18, v19
  v_pk_min_u16 v15, v10, v11
  v_pk_min_u16 v23, v18, v19
  v_pk_min_u16 v12, v12, v14
  v_pk_min_u16 v20, v20, v22
  v_pk_max_u16 v13, v13, v15
  v_pk_max_u16 v21, v21, v23
  buffer_load_dwordx4 v[52:55], v1, s[20:23], s81 offen offset:1280
  v_pk_max_u16 v12, v12, v13
  v_pk_max_u16 v20, v20, v21
  v_pk_sub_i16 v8, v8, v12
  v_pk_sub_i16 v16, v16, v20
  v_pk_sub_i16 v9, v9, v12
  v_pk_sub_i16 v17, v17, v20
  v_pk_sub_i16 v10, v10, v12
  v_pk_sub_i16 v18, v18, v20
  v_pk_sub_i16 v11, v11, v12
  v_pk_sub_i16 v19, v19, v20
  v_pk_ashrrev_i16 v8, 15, v8 op_sel_hi:[0,1]
  v_pk_ashrrev_i16 v16, 15, v16 op_sel_hi:[0,1]
  v_pk_ashrrev_i16 v9, 15, v9 op_sel_hi:[0,1]
  v_pk_ashrrev_i16 v17, 15, v17 op_sel_hi:[0,1]
  v_pk_ashrrev_i16 v10, 15, v10 op_sel_hi:[0,1]
  v_pk_ashrrev_i16 v18, 15, v18 op_sel_hi:[0,1]
  v_pk_ashrrev_i16 v11, 15, v11 op_sel_hi:[0,1]
  v_pk_ashrrev_i16 v19, 15, v19 op_sel_hi:[0,1]
  v_bfi_b32 v32, v8, 0, v32
  buffer_load_dwordx4 v[56:59], v1, s[20:23], s81 offen offset:2560
  v_bfi_b32 v33, v16, 0, v33
  v_bfi_b32 v36, v9, 0, v36
  v_bfi_b32 v37, v17, 0, v37
  v_bfi_b32 v40, v10, 0, v40
  v_bfi_b32 v41, v18, 0, v41
  v_bfi_b32 v44, v11, 0, v44
  v_bfi_b32 v45, v19, 0, v45
  v_and_b32 v8, s38, v34
  v_and_b32 v16, s38, v35
  v_and_b32 v9, s38, v38
  v_and_b32 v17, s38, v39
  v_and_b32 v10, s38, v42
  v_and_b32 v18, s38, v43
  v_and_b32 v11, s38, v46
  v_and_b32 v19, s38, v47
  v_pk_max_u16 v12, v8, v9
  v_pk_max_u16 v20, v16, v17
  v_pk_min_u16 v13, v8, v9
  v_pk_min_u16 v21, v16, v17
  v_pk_max_u16 v14, v10, v11
  buffer_load_dwordx4 v[60:63], v1, s[20:23], s81 offen offset:3840
  v_pk_max_u16 v22, v18, v19
  v_pk_min_u16 v15, v10, v11
  v_pk_min_u16 v23, v18, v19
  v_pk_min_u16 v12, v12, v14
  v_pk_min_u16 v20, v20, v22
  v_pk_max_u16 v13, v13, v15
  v_pk_max_u16 v21, v21, v23
  v_pk_max_u16 v12, v12, v13
  v_pk_max_u16 v20, v20, v21
  v_pk_sub_i16 v8, v8, v12
  v_pk_sub_i16 v16, v16, v20
  v_pk_sub_i16 v9, v9, v12
  v_pk_sub_i16 v17, v17, v20
  v_pk_sub_i16 v10, v10, v12
  v_pk_sub_i16 v18, v18, v20
  v_pk_sub_i16 v11, v11, v12
  v_pk_sub_i16 v19, v19, v20
  v_pk_ashrrev_i16 v8, 15, v8 op_sel_hi:[0,1]
  v_pk_ashrrev_i16 v16, 15, v16 op_sel_hi:[0,1]
  s_waitcnt lgkmcnt(0)
  s_barrier
  s_setprio 1
  v_pk_ashrrev_i16 v9, 15, v9 op_sel_hi:[0,1]
  v_pk_ashrrev_i16 v17, 15, v17 op_sel_hi:[0,1]
  v_pk_ashrrev_i16 v10, 15, v10 op_sel_hi:[0,1]
  v_pk_ashrrev_i16 v18, 15, v18 op_sel_hi:[0,1]
  v_pk_ashrrev_i16 v11, 15, v11 op_sel_hi:[0,1]
  v_pk_ashrrev_i16 v19, 15, v19 op_sel_hi:[0,1]
  v_bfi_b32 v34, v8, 0, v34
  v_bfi_b32 v35, v16, 0, v35
  v_bfi_b32 v38, v9, 0, v38
  v_bfi_b32 v39, v17, 0, v39
  v_bfi_b32 v42, v10, 0, v42
  v_bfi_b32 v43, v18, 0, v43
  v_bfi_b32 v46, v11, 0, v46
  v_bfi_b32 v47, v19, 0, v47
  ds_write_b128 v2, v[32:35] offset:16640
  s_add_u32 m0, s37, 61440
  s_add_u32 s56, s50, s43
  buffer_load_dwordx4 v7, s[16:19], s56 offen  lds
  ds_write_b128 v2, v[36:39] offset:16704
  s_add_u32 m0, s37, 65536
  s_add_u32 s56, s51, s43
  buffer_load_dwordx4 v7, s[16:19], s56 offen  lds
  ds_write_b128 v2, v[40:43] offset:16768
  s_add_u32 m0, s37, 69632
  s_add_u32 s56, s52, s43
  buffer_load_dwordx4 v7, s[16:19], s56 offen  lds
  ds_write_b128 v2, v[44:47] offset:16832
  s_add_u32 m0, s37, 73728
  s_add_u32 s56, s53, s43
  buffer_load_dwordx4 v7, s[16:19], s56 offen  lds
  s_setprio 0
  s_add_u32 m0, s37, 77824
  s_add_u32 s56, s54, s43
  buffer_load_dwordx4 v7, s[16:19], s56 offen  lds
  s_waitcnt lgkmcnt(0)
  s_barrier
  s_waitcnt vmcnt(5)
  buffer_load_dwordx4 v[32:35], v1, s[20:23], s82 offen offset:0
  v_and_b32 v8, s38, v48
  v_and_b32 v16, s38, v49
  v_and_b32 v9, s38, v52
  v_and_b32 v17, s38, v53
  v_and_b32 v10, s38, v56
  v_and_b32 v18, s38, v57
  v_and_b32 v11, s38, v60
  v_and_b32 v19, s38, v61
  v_pk_max_u16 v12, v8, v9
  v_pk_max_u16 v20, v16, v17
  v_pk_min_u16 v13, v8, v9
  v_pk_min_u16 v21, v16, v17
  v_pk_max_u16 v14, v10, v11
  v_pk_max_u16 v22, v18, v19
  v_pk_min_u16 v15, v10, v11
  v_pk_min_u16 v23, v18, v19
  v_pk_min_u16 v12, v12, v14
  v_pk_min_u16 v20, v20, v22
  v_pk_max_u16 v13, v13, v15
  v_pk_max_u16 v21, v21, v23
  buffer_load_dwordx4 v[36:39], v1, s[20:23], s82 offen offset:1280
  v_pk_max_u16 v12, v12, v13
  v_pk_max_u16 v20, v20, v21
  v_pk_sub_i16 v8, v8, v12
  v_pk_sub_i16 v16, v16, v20
  v_pk_sub_i16 v9, v9, v12
  v_pk_sub_i16 v17, v17, v20
  v_pk_sub_i16 v10, v10, v12
  v_pk_sub_i16 v18, v18, v20
  v_pk_sub_i16 v11, v11, v12
  v_pk_sub_i16 v19, v19, v20
  v_pk_ashrrev_i16 v8, 15, v8 op_sel_hi:[0,1]
  v_pk_ashrrev_i16 v16, 15, v16 op_sel_hi:[0,1]
  v_pk_ashrrev_i16 v9, 15, v9 op_sel_hi:[0,1]
  v_pk_ashrrev_i16 v17, 15, v17 op_sel_hi:[0,1]
  v_pk_ashrrev_i16 v10, 15, v10 op_sel_hi:[0,1]
  v_pk_ashrrev_i16 v18, 15, v18 op_sel_hi:[0,1]
  v_pk_ashrrev_i16 v11, 15, v11 op_sel_hi:[0,1]
  v_pk_ashrrev_i16 v19, 15, v19 op_sel_hi:[0,1]
  v_bfi_b32 v48, v8, 0, v48
  buffer_load_dwordx4 v[40:43], v1, s[20:23], s82 offen offset:2560
  v_bfi_b32 v49, v16, 0, v49
  v_bfi_b32 v52, v9, 0, v52
  v_bfi_b32 v53, v17, 0, v53
  v_bfi_b32 v56, v10, 0, v56
  v_bfi_b32 v57, v18, 0, v57
  v_bfi_b32 v60, v11, 0, v60
  v_bfi_b32 v61, v19, 0, v61
  v_and_b32 v8, s38, v50
  v_and_b32 v16, s38, v51
  v_and_b32 v9, s38, v54
  v_and_b32 v17, s38, v55
  v_and_b32 v10, s38, v58
  v_and_b32 v18, s38, v59
  v_and_b32 v11, s38, v62
  v_and_b32 v19, s38, v63
  v_pk_max_u16 v12, v8, v9
  v_pk_max_u16 v20, v16, v17
  v_pk_min_u16 v13, v8, v9
  v_pk_min_u16 v21, v16, v17
  v_pk_max_u16 v14, v10, v11
  buffer_load_dwordx4 v[44:47], v1, s[20:23], s82 offen offset:3840
  v_pk_max_u16 v22, v18, v19
  v_pk_min_u16 v15, v10, v11
  v_pk_min_u16 v23, v18, v19
  v_pk_min_u16 v12, v12, v14
  v_pk_min_u16 v20, v20, v22
  v_pk_max_u16 v13, v13, v15
  v_pk_max_u16 v21, v21, v23
  v_pk_max_u16 v12, v12, v13
  v_pk_max_u16 v20, v20, v21
  v_pk_sub_i16 v8, v8, v12
  v_pk_sub_i16 v16, v16, v20
  v_pk_sub_i16 v9, v9, v12
  v_pk_sub_i16 v17, v17, v20
  v_pk_sub_i16 v10, v10, v12
  v_pk_sub_i16 v18, v18, v20
  v_pk_sub_i16 v11, v11, v12
  v_pk_sub_i16 v19, v19, v20
  v_pk_ashrrev_i16 v8, 15, v8 op_sel_hi:[0,1]
  v_pk_ashrrev_i16 v16, 15, v16 op_sel_hi:[0,1]
  s_waitcnt lgkmcnt(0)
  s_barrier
  s_setprio 1
  v_pk_ashrrev_i16 v9, 15, v9 op_sel_hi:[0,1]
  v_pk_ashrrev_i16 v17, 15, v17 op_sel_hi:[0,1]
  v_pk_ashrrev_i16 v10, 15, v10 op_sel_hi:[0,1]
  v_pk_ashrrev_i16 v18, 15, v18 op_sel_hi:[0,1]
  v_pk_ashrrev_i16 v11, 15, v11 op_sel_hi:[0,1]
  v_pk_ashrrev_i16 v19, 15, v19 op_sel_hi:[0,1]
  v_bfi_b32 v50, v8, 0, v50
  v_bfi_b32 v51, v16, 0, v51
  v_bfi_b32 v54, v9, 0, v54
  v_bfi_b32 v55, v17, 0, v55
  v_bfi_b32 v58, v10, 0, v58
  v_bfi_b32 v59, v18, 0, v59
  v_bfi_b32 v62, v11, 0, v62
  v_bfi_b32 v63, v19, 0, v63
  ds_write_b128 v2, v[48:51] offset:16640
  s_add_u32 m0, s37, 102400
  s_add_u32 s56, s50, s45
  buffer_load_dwordx4 v7, s[16:19], s56 offen  lds
  ds_write_b128 v2, v[52:55] offset:16704
  s_add_u32 m0, s37, 106496
  s_add_u32 s56, s51, s45
  buffer_load_dwordx4 v7, s[16:19], s56 offen  lds
  ds_write_b128 v2, v[56:59] offset:16768
  s_add_u32 m0, s37, 110592
  s_add_u32 s56, s52, s45
  buffer_load_dwordx4 v7, s[16:19], s56 offen  lds
  ds_write_b128 v2, v[60:63] offset:16832
  s_add_u32 m0, s37, 114688
  s_add_u32 s56, s53, s45
  buffer_load_dwordx4 v7, s[16:19], s56 offen  lds
  s_setprio 0
  s_add_u32 m0, s37, 118784
  s_add_u32 s56, s54, s45
  buffer_load_dwordx4 v7, s[16:19], s56 offen  lds
  s_waitcnt vmcnt(9)
  s_waitcnt lgkmcnt(0)
  s_barrier
  s_waitcnt vmcnt(5)
  buffer_load_dwordx4 v[48:51], v1, s[20:23], s83 offen offset:0
  v_and_b32 v8, s38, v32
  v_and_b32 v16, s38, v33
  v_and_b32 v9, s38, v36
  v_and_b32 v17, s38, v37
  v_and_b32 v10, s38, v40
  v_and_b32 v18, s38, v41
  v_and_b32 v11, s38, v44
  v_and_b32 v19, s38, v45
  v_pk_max_u16 v12, v8, v9
  v_pk_max_u16 v20, v16, v17
  v_pk_min_u16 v13, v8, v9
  v_pk_min_u16 v21, v16, v17
  v_pk_max_u16 v14, v10, v11
  v_pk_max_u16 v22, v18, v19
  v_pk_min_u16 v15, v10, v11
  v_pk_min_u16 v23, v18, v19
  v_pk_min_u16 v12, v12, v14
  v_pk_min_u16 v20, v20, v22
  v_pk_max_u16 v13, v13, v15
  v_pk_max_u16 v21, v21, v23
  buffer_load_dwordx4 v[52:55], v1, s[20:23], s83 offen offset:1280
  v_pk_max_u16 v12, v12, v13
  v_pk_max_u16 v20, v20, v21
  v_pk_sub_i16 v8, v8, v12
  v_pk_sub_i16 v16, v16, v20
  v_pk_sub_i16 v9, v9, v12
  v_pk_sub_i16 v17, v17, v20
  v_pk_sub_i16 v10, v10, v12
  v_pk_sub_i16 v18, v18, v20
  v_pk_sub_i16 v11, v11, v12
  v_pk_sub_i16 v19, v19, v20
  v_pk_ashrrev_i16 v8, 15, v8 op_sel_hi:[0,1]
  v_pk_ashrrev_i16 v16, 15, v16 op_sel_hi:[0,1]
  v_pk_ashrrev_i16 v9, 15, v9 op_sel_hi:[0,1]
  v_pk_ashrrev_i16 v17, 15, v17 op_sel_hi:[0,1]
  v_pk_ashrrev_i16 v10, 15, v10 op_sel_hi:[0,1]
  v_pk_ashrrev_i16 v18, 15, v18 op_sel_hi:[0,1]
  v_pk_ashrrev_i16 v11, 15, v11 op_sel_hi:[0,1]
  v_pk_ashrrev_i16 v19, 15, v19 op_sel_hi:[0,1]
  v_bfi_b32 v32, v8, 0, v32
  buffer_load_dwordx4 v[56:59], v1, s[20:23], s83 offen offset:2560
  v_bfi_b32 v33, v16, 0, v33
  v_bfi_b32 v36, v9, 0, v36
  v_bfi_b32 v37, v17, 0, v37
  v_bfi_b32 v40, v10, 0, v40
  v_bfi_b32 v41, v18, 0, v41
  v_bfi_b32 v44, v11, 0, v44
  v_bfi_b32 v45, v19, 0, v45
  v_and_b32 v8, s38, v34
  v_and_b32 v16, s38, v35
  v_and_b32 v9, s38, v38
  v_and_b32 v17, s38, v39
  v_and_b32 v10, s38, v42
  v_and_b32 v18, s38, v43
  v_and_b32 v11, s38, v46
  v_and_b32 v19, s38, v47
  v_pk_max_u16 v12, v8, v9
  v_pk_max_u16 v20, v16, v17
  v_pk_min_u16 v13, v8, v9
  v_pk_min_u16 v21, v16, v17
  v_pk_max_u16 v14, v10, v11
  buffer_load_dwordx4 v[60:63], v1, s[20:23], s83 offen offset:3840
  v_pk_max_u16 v22, v18, v19
  v_pk_min_u16 v15, v10, v11
  v_pk_min_u16 v23, v18, v19
  v_pk_min_u16 v12, v12, v14
  v_pk_min_u16 v20, v20, v22
  v_pk_max_u16 v13, v13, v15
  v_pk_max_u16 v21, v21, v23
  v_pk_max_u16 v12, v12, v13
  v_pk_max_u16 v20, v20, v21
  v_pk_sub_i16 v8, v8, v12
  v_pk_sub_i16 v16, v16, v20
  v_pk_sub_i16 v9, v9, v12
  v_pk_sub_i16 v17, v17, v20
  v_pk_sub_i16 v10, v10, v12
  v_pk_sub_i16 v18, v18, v20
  v_pk_sub_i16 v11, v11, v12
  v_pk_sub_i16 v19, v19, v20
  v_pk_ashrrev_i16 v8, 15, v8 op_sel_hi:[0,1]
  v_pk_ashrrev_i16 v16, 15, v16 op_sel_hi:[0,1]
  s_waitcnt lgkmcnt(0)
  s_barrier
  s_setprio 1
  v_pk_ashrrev_i16 v9, 15, v9 op_sel_hi:[0,1]
  v_pk_ashrrev_i16 v17, 15, v17 op_sel_hi:[0,1]
  v_pk_ashrrev_i16 v10, 15, v10 op_sel_hi:[0,1]
  v_pk_ashrrev_i16 v18, 15, v18 op_sel_hi:[0,1]
  v_pk_ashrrev_i16 v11, 15, v11 op_sel_hi:[0,1]
  v_pk_ashrrev_i16 v19, 15, v19 op_sel_hi:[0,1]
  v_bfi_b32 v34, v8, 0, v34
  v_bfi_b32 v35, v16, 0, v35
  v_bfi_b32 v38, v9, 0, v38
  v_bfi_b32 v39, v17, 0, v39
  v_bfi_b32 v42, v10, 0, v42
  v_bfi_b32 v43, v18, 0, v43
  v_bfi_b32 v46, v11, 0, v46
  v_bfi_b32 v47, v19, 0, v47
  ds_write_b128 v2, v[32:35] offset:16640
  s_add_u32 m0, s37, 16384
  s_add_u32 s56, s50, s47
  buffer_load_dwordx4 v7, s[16:19], s56 offen  lds
  ds_write_b128 v2, v[36:39] offset:16704
  s_add_u32 m0, s37, 20480
  s_add_u32 s56, s51, s47
  buffer_load_dwordx4 v7, s[16:19], s56 offen  lds
  ds_write_b128 v2, v[40:43] offset:16768
  s_add_u32 m0, s37, 24576
  s_add_u32 s56, s52, s47
  buffer_load_dwordx4 v7, s[16:19], s56 offen  lds
  ds_write_b128 v2, v[44:47] offset:16832
  s_add_u32 m0, s37, 28672
  s_add_u32 s56, s53, s47
  buffer_load_dwordx4 v7, s[16:19], s56 offen  lds
  s_setprio 0
  s_add_u32 m0, s37, 32768
  s_add_u32 s56, s54, s47
  buffer_load_dwordx4 v7, s[16:19], s56 offen  lds
  s_waitcnt vmcnt(9)
  s_waitcnt lgkmcnt(0)
  s_barrier
  s_waitcnt vmcnt(5)
  buffer_load_dwordx4 v[32:35], v1, s[20:23], s84 offen offset:0
  v_and_b32 v8, s38, v48
  v_and_b32 v16, s38, v49
  v_and_b32 v9, s38, v52
  v_and_b32 v17, s38, v53
  v_and_b32 v10, s38, v56
  v_and_b32 v18, s38, v57
  v_and_b32 v11, s38, v60
  v_and_b32 v19, s38, v61
  v_pk_max_u16 v12, v8, v9
  v_pk_max_u16 v20, v16, v17
  v_pk_min_u16 v13, v8, v9
  v_pk_min_u16 v21, v16, v17
  v_pk_max_u16 v14, v10, v11
  v_pk_max_u16 v22, v18, v19
  v_pk_min_u16 v15, v10, v11
  v_pk_min_u16 v23, v18, v19
  v_pk_min_u16 v12, v12, v14
  v_pk_min_u16 v20, v20, v22
  v_pk_max_u16 v13, v13, v15
  v_pk_max_u16 v21, v21, v23
  buffer_load_dwordx4 v[36:39], v1, s[20:23], s84 offen offset:1280
  v_pk_max_u16 v12, v12, v13
  v_pk_max_u16 v20, v20, v21
  v_pk_sub_i16 v8, v8, v12
  v_pk_sub_i16 v16, v16, v20
  v_pk_sub_i16 v9, v9, v12
  v_pk_sub_i16 v17, v17, v20
  v_pk_sub_i16 v10, v10, v12
  v_pk_sub_i16 v18, v18, v20
  v_pk_sub_i16 v11, v11, v12
  v_pk_sub_i16 v19, v19, v20
  v_pk_ashrrev_i16 v8, 15, v8 op_sel_hi:[0,1]
  v_pk_ashrrev_i16 v16, 15, v16 op_sel_hi:[0,1]
  v_pk_ashrrev_i16 v9, 15, v9 op_sel_hi:[0,1]
  v_pk_ashrrev_i16 v17, 15, v17 op_sel_hi:[0,1]
  v_pk_ashrrev_i16 v10, 15, v10 op_sel_hi:[0,1]
  v_pk_ashrrev_i16 v18, 15, v18 op_sel_hi:[0,1]
  v_pk_ashrrev_i16 v11, 15, v11 op_sel_hi:[0,1]
  v_pk_ashrrev_i16 v19, 15, v19 op_sel_hi:[0,1]
  v_bfi_b32 v48, v8, 0, v48
  buffer_load_dwordx4 v[40:43], v1, s[20:23], s84 offen offset:2560
  v_bfi_b32 v49, v16, 0, v49
  v_bfi_b32 v52, v9, 0, v52
  v_bfi_b32 v53, v17, 0, v53
  v_bfi_b32 v56, v10, 0, v56
  v_bfi_b32 v57, v18, 0, v57
  v_bfi_b32 v60, v11, 0, v60
  v_bfi_b32 v61, v19, 0, v61
  v_and_b32 v8, s38, v50
  v_and_b32 v16, s38, v51
  v_and_b32 v9, s38, v54
  v_and_b32 v17, s38, v55
  v_and_b32 v10, s38, v58
  v_and_b32 v18, s38, v59
  v_and_b32 v11, s38, v62
  v_and_b32 v19, s38, v63
  v_pk_max_u16 v12, v8, v9
  v_pk_max_u16 v20, v16, v17
  v_pk_min_u16 v13, v8, v9
  v_pk_min_u16 v21, v16, v17
  v_pk_max_u16 v14, v10, v11
  buffer_load_dwordx4 v[44:47], v1, s[20:23], s84 offen offset:3840
  v_pk_max_u16 v22, v18, v19
  v_pk_min_u16 v15, v10, v11
  v_pk_min_u16 v23, v18, v19
  v_pk_min_u16 v12, v12, v14
  v_pk_min_u16 v20, v20, v22
  v_pk_max_u16 v13, v13, v15
  v_pk_max_u16 v21, v21, v23
  v_pk_max_u16 v12, v12, v13
  v_pk_max_u16 v20, v20, v21
  v_pk_sub_i16 v8, v8, v12
  v_pk_sub_i16 v16, v16, v20
  v_pk_sub_i16 v9, v9, v12
  v_pk_sub_i16 v17, v17, v20
  v_pk_sub_i16 v10, v10, v12
  v_pk_sub_i16 v18, v18, v20
  v_pk_sub_i16 v11, v11, v12
  v_pk_sub_i16 v19, v19, v20
  v_pk_ashrrev_i16 v8, 15, v8 op_sel_hi:[0,1]
  v_pk_ashrrev_i16 v16, 15, v16 op_sel_hi:[0,1]
  s_waitcnt lgkmcnt(0)
  s_barrier
  s_setprio 1
  v_pk_ashrrev_i16 v9, 15, v9 op_sel_hi:[0,1]
  v_pk_ashrrev_i16 v17, 15, v17 op_sel_hi:[0,1]
  v_pk_ashrrev_i16 v10, 15, v10 op_sel_hi:[0,1]
  v_pk_ashrrev_i16 v18, 15, v18 op_sel_hi:[0,1]
  v_pk_ashrrev_i16 v11, 15, v11 op_sel_hi:[0,1]
  v_pk_ashrrev_i16 v19, 15, v19 op_sel_hi:[0,1]
  v_bfi_b32 v50, v8, 0, v50
  v_bfi_b32 v51, v16, 0, v51
  v_bfi_b32 v54, v9, 0, v54
  v_bfi_b32 v55, v17, 0, v55
  v_bfi_b32 v58, v10, 0, v58
  v_bfi_b32 v59, v18, 0, v59
  v_bfi_b32 v62, v11, 0, v62
  v_bfi_b32 v63, v19, 0, v63
  ds_write_b128 v2, v[48:51] offset:16640
  s_add_u32 m0, s37, 57344
  s_add_u32 s56, s50, s49
  buffer_load_dwordx4 v7, s[16:19], s56 offen  lds
  ds_write_b128 v2, v[52:55] offset:16704
  s_add_u32 m0, s37, 61440
  s_add_u32 s56, s51, s49
  buffer_load_dwordx4 v7, s[16:19], s56 offen  lds
  ds_write_b128 v2, v[56:59] offset:16768
  s_add_u32 m0, s37, 65536
  s_add_u32 s56, s52, s49
  buffer_load_dwordx4 v7, s[16:19], s56 offen  lds
  ds_write_b128 v2, v[60:63] offset:16832
  s_add_u32 m0, s37, 69632
  s_add_u32 s56, s53, s49
  buffer_load_dwordx4 v7, s[16:19], s56 offen  lds
  s_setprio 0
  s_add_u32 m0, s37, 73728
  s_add_u32 s56, s54, s49
  buffer_load_dwordx4 v7, s[16:19], s56 offen  lds
  s_waitcnt vmcnt(9)
  s_waitcnt lgkmcnt(0)
  s_barrier
  s_waitcnt vmcnt(5)
  v_and_b32 v8, s38, v32
  v_and_b32 v16, s38, v33
  v_and_b32 v9, s38, v36
  v_and_b32 v17, s38, v37
  v_and_b32 v10, s38, v40
  v_and_b32 v18, s38, v41
  v_and_b32 v11, s38, v44
  v_and_b32 v19, s38, v45
  v_pk_max_u16 v12, v8, v9
  v_pk_max_u16 v20, v16, v17
  v_pk_min_u16 v13, v8, v9
  v_pk_min_u16 v21, v16, v17
  v_pk_max_u16 v14, v10, v11
  v_pk_max_u16 v22, v18, v19
  v_pk_min_u16 v15, v10, v11
  v_pk_min_u16 v23, v18, v19
  v_pk_min_u16 v12, v12, v14
  v_pk_min_u16 v20, v20, v22
  v_pk_max_u16 v13, v13, v15
  v_pk_max_u16 v21, v21, v23
  v_pk_max_u16 v12, v12, v13
  v_pk_max_u16 v20, v20, v21
  v_pk_sub_i16 v8, v8, v12
  v_pk_sub_i16 v16, v16, v20
  v_pk_sub_i16 v9, v9, v12
  v_pk_sub_i16 v17, v17, v20
  v_pk_sub_i16 v10, v10, v12
  v_pk_sub_i16 v18, v18, v20
  v_pk_sub_i16 v11, v11, v12
  v_pk_sub_i16 v19, v19, v20
  v_pk_ashrrev_i16 v8, 15, v8 op_sel_hi:[0,1]
  v_pk_ashrrev_i16 v16, 15, v16 op_sel_hi:[0,1]
  v_pk_ashrrev_i16 v9, 15, v9 op_sel_hi:[0,1]
  v_pk_ashrrev_i16 v17, 15, v17 op_sel_hi:[0,1]
  v_pk_ashrrev_i16 v10, 15, v10 op_sel_hi:[0,1]
  v_pk_ashrrev_i16 v18, 15, v18 op_sel_hi:[0,1]
  v_pk_ashrrev_i16 v11, 15, v11 op_sel_hi:[0,1]
  v_pk_ashrrev_i16 v19, 15, v19 op_sel_hi:[0,1]
  v_bfi_b32 v32, v8, 0, v32
  v_bfi_b32 v33, v16, 0, v33
  v_bfi_b32 v36, v9, 0, v36
  v_bfi_b32 v37, v17, 0, v37
  v_bfi_b32 v40, v10, 0, v40
  v_bfi_b32 v41, v18, 0, v41
  v_bfi_b32 v44, v11, 0, v44
  v_bfi_b32 v45, v19, 0, v45
  v_and_b32 v8, s38, v34
  v_and_b32 v16, s38, v35
  v_and_b32 v9, s38, v38
  v_and_b32 v17, s38, v39
  v_and_b32 v10, s38, v42
  v_and_b32 v18, s38, v43
  v_and_b32 v11, s38, v46
  v_and_b32 v19, s38, v47
  v_pk_max_u16 v12, v8, v9
  v_pk_max_u16 v20, v16, v17
  v_pk_min_u16 v13, v8, v9
  v_pk_min_u16 v21, v16, v17
  v_pk_max_u16 v14, v10, v11
  v_pk_max_u16 v22, v18, v19
  v_pk_min_u16 v15, v10, v11
  v_pk_min_u16 v23, v18, v19
  v_pk_min_u16 v12, v12, v14
  v_pk_min_u16 v20, v20, v22
  v_pk_max_u16 v13, v13, v15
  v_pk_max_u16 v21, v21, v23
  v_pk_max_u16 v12, v12, v13
  v_pk_max_u16 v20, v20, v21
  v_pk_sub_i16 v8, v8, v12
  v_pk_sub_i16 v16, v16, v20
  v_pk_sub_i16 v9, v9, v12
  v_pk_sub_i16 v17, v17, v20
  v_pk_sub_i16 v10, v10, v12
  v_pk_sub_i16 v18, v18, v20
  v_pk_sub_i16 v11, v11, v12
  v_pk_sub_i16 v19, v19, v20
  v_pk_ashrrev_i16 v8, 15, v8 op_sel_hi:[0,1]
  v_pk_ashrrev_i16 v16, 15, v16 op_sel_hi:[0,1]
  s_waitcnt lgkmcnt(0)
  s_barrier
  s_setprio 1
  v_pk_ashrrev_i16 v9, 15, v9 op_sel_hi:[0,1]
  v_pk_ashrrev_i16 v17, 15, v17 op_sel_hi:[0,1]
  v_pk_ashrrev_i16 v10, 15, v10 op_sel_hi:[0,1]
  v_pk_ashrrev_i16 v18, 15, v18 op_sel_hi:[0,1]
  v_pk_ashrrev_i16 v11, 15, v11 op_sel_hi:[0,1]
  v_pk_ashrrev_i16 v19, 15, v19 op_sel_hi:[0,1]
  v_bfi_b32 v34, v8, 0, v34
  v_bfi_b32 v35, v16, 0, v35
  v_bfi_b32 v38, v9, 0, v38
  v_bfi_b32 v39, v17, 0, v39
  v_bfi_b32 v42, v10, 0, v42
  v_bfi_b32 v43, v18, 0, v43
  v_bfi_b32 v46, v11, 0, v46
  v_bfi_b32 v47, v19, 0, v47
  ds_write_b128 v2, v[32:35] offset:16640
  ds_write_b128 v2, v[36:39] offset:16704
  ds_write_b128 v2, v[40:43] offset:16768
  ds_write_b128 v2, v[44:47] offset:16832
  s_setprio 0
  s_waitcnt vmcnt(0)
  s_waitcnt lgkmcnt(0)
  s_barrier
  v_subrev_u32 v29, 126976, v3
L_poll5_1_0:
  ds_read_b32 v28, v5 offset:0
  ds_read_b128 v[64:67], v3 offset:0
  s_waitcnt lgkmcnt(0)
  v_cmp_ne_u32 vcc, s3, v28
  s_cbranch_vccnz L_poll5_1_0
  buffer_store_dwordx4 v[64:67], v4, s[24:27], s90 offen sc1
L_poll5_1_1:
  ds_read_b32 v28, v5 offset:4
  ds_read_b128 v[68:71], v3 offset:2048
  s_waitcnt lgkmcnt(0)
  v_cmp_ne_u32 vcc, s3, v28
  s_cbranch_vccnz L_poll5_1_1
  buffer_store_dwordx4 v[68:71], v4, s[24:27], s91 offen sc1
L_poll5_1_2:
  ds_read_b32 v28, v5 offset:8
  ds_read_b128 v[72:75], v3 offset:16640
  s_waitcnt lgkmcnt(0)
  v_cmp_ne_u32 vcc, s3, v28
  s_cbranch_vccnz L_poll5_1_2
  buffer_store_dwordx4 v[72:75], v4, s[24:27], s92 offen sc1
L_poll5_1_3:
  ds_read_b32 v28, v5 offset:12
  ds_read_b128 v[76:79], v3 offset:18688
  s_waitcnt lgkmcnt(0)
  v_cmp_ne_u32 vcc, s3, v28
  s_cbranch_vccnz L_poll5_1_3
  buffer_store_dwordx4 v[76:79], v4, s[24:27], s93 offen sc1
L_poll5_1_4:
  ds_read_b32 v28, v5 offset:16
  ds_read_b128 v[80:83], v29 offset:0
  s_waitcnt lgkmcnt(0)
  v_cmp_ne_u32 vcc, s3, v28
  s_cbranch_vccnz L_poll5_1_4
  buffer_store_dwordx4 v[80:83], v4, s[24:27], s94 offen sc1
  s_endpgm
L_c5:
  s_movk_i32 s57, 640
  s_mov_b32 s58, 0
  s_add_u32 s42, s41, 128
  s_cmp_eq_u32 s42, s57
  s_cselect_b32 s42, s58, s42
  s_add_u32 m0, s37, 40960
  s_add_u32 s56, s50, s42
  buffer_load_dwordx4 v153, s[16:19], s56 offen  lds
  s_add_u32 m0, s37, 45056
  s_add_u32 s56, s51, s42
  buffer_load_dwordx4 v153, s[16:19], s56 offen  lds
  s_add_u32 m0, s37, 49152
  s_add_u32 s56, s52, s42
  buffer_load_dwordx4 v153, s[16:19], s56 offen  lds
  s_add_u32 m0, s37, 53248
  s_add_u32 s56, s53, s42
  buffer_load_dwordx4 v153, s[16:19], s56 offen  lds
  s_add_u32 m0, s37, 57344
  s_add_u32 s56, s54, s42
  buffer_load_dwordx4 v153, s[16:19], s56 offen  lds
  v_and_b32 v2, 31, v1
  v_lshrrev_b32 v3, 5, v1
  v_lshrrev_b32 v4, 1, v2
  v_and_b32 v4, 7, v4
  v_xor_b32 v4, v4, v3
  v_lshlrev_b32 v4, 4, v4
  v_lshl_add_u32 v148, v2, 7, v4
  v_xor_b32 v149, 32, v148
  v_xor_b32 v150, 64, v148
  v_xor_b32 v151, 96, v148
  v_lshlrev_b32 v4, 9, v3
  v_bfe_u32 v5, v1, 4, 1
  v_lshl_add_u32 v4, v5, 5, v4
  v_bfe_u32 v5, v1, 2, 2
  v_lshl_add_u32 v4, v5, 6, v4
  v_and_b32 v5, 3, v1
  v_lshl_add_u32 v4, v5, 3, v4
  s_mul_i32 s56, s32, 4160
  s_add_u32 s56, s56, 126976
  v_add_u32 v152, s56, v4
  v_bfe_u32 v5, v1, 1, 2
  v_xor_b32 v5, v5, v3
  v_lshlrev_b32 v5, 4, v5
  v_lshl_add_u32 v5, v2, 6, v5
  v_add_u32 v154, s56, v5
  s_lshl_b32 s56, s32, 7
  s_add_u32 s56, s56, 160256
  v_lshlrev_b32 v4, 4, v3
  v_add_u32 v155, s56, v4
  s_setprio 3
  s_waitcnt vmcnt(10)
  s_barrier
  ds_read_b64_tr_b16 v[96:97], v152 offset:0
  ds_read_b64_tr_b16 v[98:99], v152 offset:256
  ds_read_b128 v[64:67], v155 offset:0
  ds_read_b128 v[68:71], v155 offset:32
  ds_read_b128 v[72:75], v155 offset:64
  ds_read_b128 v[76:79], v155 offset:96
  ds_read_b128 v[128:131], v148 offset:0
  ds_read_b64_tr_b16 v[100:101], v152 offset:1024
  ds_read_b64_tr_b16 v[102:103], v152 offset:1280
  ds_read_b128 v[132:135], v149 offset:0
  ds_read_b64_tr_b16 v[104:105], v152 offset:2048
  ds_read_b64_tr_b16 v[106:107], v152 offset:2304
  ds_read_b128 v[136:139], v150 offset:0
  ds_read_b64_tr_b16 v[108:109], v152 offset:3072
  ds_read_b64_tr_b16 v[110:111], v152 offset:3328
  s_waitcnt lgkmcnt(13)
  ds_read_b128 v[140:143], v151 offset:0
  ds_read_b128 v[144:147], v148 offset:4096
  s_waitcnt lgkmcnt(10)
  v_mfma_f32_32x32x16_bf16 v[0:15], v[96:99], v[128:131], v[64:79]
  ds_read_b128 v[128:131], v149 offset:4096
  s_waitcnt lgkmcnt(8)
  v_mfma_f32_32x32x16_bf16 v[0:15], v[100:103], v[132:135], v[0:15]
  ds_read_b128 v[132:135], v150 offset:4096
  s_waitcnt lgkmcnt(6)
  v_mfma_f32_32x32x16_bf16 v[0:15], v[104:107], v[136:139], v[0:15]
  ds_read_b128 v[136:139], v151 offset:4096
  s_waitcnt lgkmcnt(4)
  v_mfma_f32_32x32x16_bf16 v[0:15], v[108:111], v[140:143], v[0:15]
  ds_read_b128 v[140:143], v148 offset:8192
  s_waitcnt lgkmcnt(4)
  v_mfma_f32_32x32x16_bf16 v[16:31], v[96:99], v[144:147], v[64:79]
  ds_read_b128 v[144:147], v149 offset:8192
  s_waitcnt lgkmcnt(4)
  v_mfma_f32_32x32x16_bf16 v[16:31], v[100:103], v[128:131], v[16:31]
  ds_read_b128 v[128:131], v150 offset:8192
  s_waitcnt lgkmcnt(4)
  v_mfma_f32_32x32x16_bf16 v[16:31], v[104:107], v[132:135], v[16:31]
  ds_read_b128 v[132:135], v151 offset:8192
  s_waitcnt lgkmcnt(4)
  v_mfma_f32_32x32x16_bf16 v[16:31], v[108:111], v[136:139], v[16:31]
  ds_read_b128 v[136:139], v148 offset:12288
  s_add_u32 s56, s32, 160768
  v_mov_b32 v153, s56
  v_mov_b32 v155, 1
  s_waitcnt lgkmcnt(4)
  v_mfma_f32_32x32x16_bf16 v[32:47], v[96:99], v[140:143], v[64:79]
  ds_read_b128 v[140:143], v149 offset:12288
  s_waitcnt lgkmcnt(4)
  v_mfma_f32_32x32x16_bf16 v[32:47], v[100:103], v[144:147], v[32:47]
  ds_read_b128 v[144:147], v150 offset:12288
  s_waitcnt lgkmcnt(4)
  v_mfma_f32_32x32x16_bf16 v[32:47], v[104:107], v[128:131], v[32:47]
  ds_read_b128 v[128:131], v151 offset:12288
  s_waitcnt lgkmcnt(4)
  v_mfma_f32_32x32x16_bf16 v[32:47], v[108:111], v[132:135], v[32:47]
  ds_read_b128 v[132:135], v148 offset:16384
  s_waitcnt lgkmcnt(4)
  v_mfma_f32_32x32x16_bf16 v[48:63], v[96:99], v[136:139], v[64:79]
  ds_read_b128 v[136:139], v149 offset:16384
  s_waitcnt lgkmcnt(4)
  v_mfma_f32_32x32x16_bf16 v[48:63], v[100:103], v[140:143], v[48:63]
  ds_read_b128 v[140:143], v150 offset:16384
  s_waitcnt lgkmcnt(4)
  v_mfma_f32_32x32x16_bf16 v[48:63], v[104:107], v[144:147], v[48:63]
  ds_read_b128 v[144:147], v151 offset:16384
  s_waitcnt lgkmcnt(4)
  v_mfma_f32_32x32x16_bf16 v[48:63], v[108:111], v[128:131], v[48:63]
  s_waitcnt vmcnt(5)
  s_barrier
  ds_read_b128 v[128:131], v148 offset:20480
  ds_read_b64_tr_b16 v[112:113], v152 offset:16640
  ds_read_b64_tr_b16 v[114:115], v152 offset:16896
  s_waitcnt lgkmcnt(6)
  v_mfma_f32_32x32x16_bf16 v[64:79], v[96:99], v[132:135], v[64:79]
  ds_read_b128 v[132:135], v149 offset:20480
  ds_read_b64_tr_b16 v[116:117], v152 offset:17664
  ds_read_b64_tr_b16 v[118:119], v152 offset:17920
  s_waitcnt lgkmcnt(8)
  v_mfma_f32_32x32x16_bf16 v[64:79], v[100:103], v[136:139], v[64:79]
  ds_read_b128 v[136:139], v150 offset:20480
  ds_read_b64_tr_b16 v[120:121], v152 offset:18688
  ds_read_b64_tr_b16 v[122:123], v152 offset:18944
  s_waitcnt lgkmcnt(10)
  v_mfma_f32_32x32x16_bf16 v[64:79], v[104:107], v[140:143], v[64:79]
  ds_read_b128 v[140:143], v151 offset:20480
  ds_read_b64_tr_b16 v[124:125], v152 offset:19712
  ds_read_b64_tr_b16 v[126:127], v152 offset:19968
  s_waitcnt lgkmcnt(12)
  v_mfma_f32_32x32x16_bf16 v[64:79], v[108:111], v[144:147], v[64:79]
  ds_read_b128 v[144:147], v148 offset:24576
  s_waitcnt lgkmcnt(10)
  v_mfma_f32_32x32x16_bf16 v[0:15], v[112:115], v[128:131], v[0:15]
  ds_read_b128 v[128:131], v149 offset:24576
  s_waitcnt lgkmcnt(8)
  v_mfma_f32_32x32x16_bf16 v[0:15], v[116:119], v[132:135], v[0:15]
  ds_read_b128 v[132:135], v150 offset:24576
  s_waitcnt lgkmcnt(6)
  v_mfma_f32_32x32x16_bf16 v[0:15], v[120:123], v[136:139], v[0:15]
  ds_read_b128 v[136:139], v151 offset:24576
  s_waitcnt lgkmcnt(4)
  v_mfma_f32_32x32x16_bf16 v[0:15], v[124:127], v[140:143], v[0:15]
  ds_read_b128 v[140:143], v148 offset:28672
  s_waitcnt lgkmcnt(4)
  v_mfma_f32_32x32x16_bf16 v[16:31], v[112:115], v[144:147], v[16:31]
  ds_read_b128 v[144:147], v149 offset:28672
  s_waitcnt lgkmcnt(4)
  v_mfma_f32_32x32x16_bf16 v[16:31], v[116:119], v[128:131], v[16:31]
  ds_read_b128 v[128:131], v150 offset:28672
  s_waitcnt lgkmcnt(4)
  v_mfma_f32_32x32x16_bf16 v[16:31], v[120:123], v[132:135], v[16:31]
  ds_read_b128 v[132:135], v151 offset:28672
  s_waitcnt lgkmcnt(4)
  v_mfma_f32_32x32x16_bf16 v[16:31], v[124:127], v[136:139], v[16:31]
  ds_read_b128 v[136:139], v148 offset:32768
  s_waitcnt lgkmcnt(4)
  v_mfma_f32_32x32x16_bf16 v[32:47], v[112:115], v[140:143], v[32:47]
  ds_read_b128 v[140:143], v149 offset:32768
  s_waitcnt lgkmcnt(4)
  v_mfma_f32_32x32x16_bf16 v[32:47], v[116:119], v[144:147], v[32:47]
  ds_read_b128 v[144:147], v150 offset:32768
  s_waitcnt lgkmcnt(4)
  v_mfma_f32_32x32x16_bf16 v[32:47], v[120:123], v[128:131], v[32:47]
  ds_read_b128 v[128:131], v151 offset:32768
  s_waitcnt lgkmcnt(4)
  v_mfma_f32_32x32x16_bf16 v[32:47], v[124:127], v[132:135], v[32:47]
  ds_read_b128 v[132:135], v148 offset:36864
  s_waitcnt lgkmcnt(4)
  v_mfma_f32_32x32x16_bf16 v[48:63], v[112:115], v[136:139], v[48:63]
  ds_read_b128 v[136:139], v149 offset:36864
  s_waitcnt lgkmcnt(4)
  v_mfma_f32_32x32x16_bf16 v[48:63], v[116:119], v[140:143], v[48:63]
  ds_read_b128 v[140:143], v150 offset:36864
  s_waitcnt lgkmcnt(4)
  v_mfma_f32_32x32x16_bf16 v[48:63], v[120:123], v[144:147], v[48:63]
  ds_read_b128 v[144:147], v151 offset:36864
  s_waitcnt lgkmcnt(4)
  v_mfma_f32_32x32x16_bf16 v[48:63], v[124:127], v[128:131], v[48:63]
  s_waitcnt vmcnt(0)
  s_barrier
  ds_read_b128 v[128:131], v148 offset:40960
  ds_read_b64_tr_b16 v[96:97], v152 offset:0
  ds_read_b64_tr_b16 v[98:99], v152 offset:256
  s_waitcnt lgkmcnt(6)
  v_mfma_f32_32x32x16_bf16 v[64:79], v[112:115], v[132:135], v[64:79]
  ds_read_b128 v[132:135], v149 offset:40960
  ds_read_b64_tr_b16 v[100:101], v152 offset:1024
  ds_read_b64_tr_b16 v[102:103], v152 offset:1280
  s_waitcnt lgkmcnt(8)
  v_mfma_f32_32x32x16_bf16 v[64:79], v[116:119], v[136:139], v[64:79]
  ds_read_b128 v[136:139], v150 offset:40960
  ds_read_b64_tr_b16 v[104:105], v152 offset:2048
  ds_read_b64_tr_b16 v[106:107], v152 offset:2304
  s_waitcnt lgkmcnt(10)
  v_mfma_f32_32x32x16_bf16 v[64:79], v[120:123], v[140:143], v[64:79]
  ds_read_b128 v[140:143], v151 offset:40960
  ds_read_b64_tr_b16 v[108:109], v152 offset:3072
  ds_read_b64_tr_b16 v[110:111], v152 offset:3328
  s_waitcnt lgkmcnt(12)
  v_mfma_f32_32x32x16_bf16 v[64:79], v[124:127], v[144:147], v[64:79]
  ds_read_b128 v[144:147], v148 offset:45056
  s_waitcnt lgkmcnt(10)
  v_mfma_f32_32x32x16_bf16 v[0:15], v[96:99], v[128:131], v[0:15]
  ds_read_b128 v[128:131], v149 offset:45056
  s_waitcnt lgkmcnt(8)
  v_mfma_f32_32x32x16_bf16 v[0:15], v[100:103], v[132:135], v[0:15]
  ds_read_b128 v[132:135], v150 offset:45056
  s_waitcnt lgkmcnt(6)
  v_mfma_f32_32x32x16_bf16 v[0:15], v[104:107], v[136:139], v[0:15]
  ds_read_b128 v[136:139], v151 offset:45056
  s_waitcnt lgkmcnt(4)
  v_mfma_f32_32x32x16_bf16 v[0:15], v[108:111], v[140:143], v[0:15]
  ds_read_b128 v[140:143], v148 offset:49152
  s_waitcnt lgkmcnt(4)
  v_mfma_f32_32x32x16_bf16 v[16:31], v[96:99], v[144:147], v[16:31]
  ds_read_b128 v[144:147], v149 offset:49152
  s_waitcnt lgkmcnt(4)
  v_mfma_f32_32x32x16_bf16 v[16:31], v[100:103], v[128:131], v[16:31]
  ds_read_b128 v[128:131], v150 offset:49152
  s_waitcnt lgkmcnt(4)
  v_mfma_f32_32x32x16_bf16 v[16:31], v[104:107], v[132:135], v[16:31]
  ds_read_b128 v[132:135], v151 offset:49152
  s_waitcnt lgkmcnt(4)
  v_mfma_f32_32x32x16_bf16 v[16:31], v[108:111], v[136:139], v[16:31]
  ds_read_b128 v[136:139], v148 offset:53248
  s_waitcnt lgkmcnt(4)
  v_mfma_f32_32x32x16_bf16 v[32:47], v[96:99], v[140:143], v[32:47]
  ds_read_b128 v[140:143], v149 offset:53248
  s_waitcnt lgkmcnt(4)
  v_mfma_f32_32x32x16_bf16 v[32:47], v[100:103], v[144:147], v[32:47]
  ds_read_b128 v[144:147], v150 offset:53248
  s_waitcnt lgkmcnt(4)
  v_mfma_f32_32x32x16_bf16 v[32:47], v[104:107], v[128:131], v[32:47]
  ds_read_b128 v[128:131], v151 offset:53248
  s_waitcnt lgkmcnt(4)
  v_mfma_f32_32x32x16_bf16 v[32:47], v[108:111], v[132:135], v[32:47]
  ds_read_b128 v[132:135], v148 offset:57344
  s_waitcnt lgkmcnt(4)
  v_mfma_f32_32x32x16_bf16 v[48:63], v[96:99], v[136:139], v[48:63]
  ds_read_b128 v[136:139], v149 offset:57344
  s_waitcnt lgkmcnt(4)
  v_mfma_f32_32x32x16_bf16 v[48:63], v[100:103], v[140:143], v[48:63]
  ds_read_b128 v[140:143], v150 offset:57344
  s_waitcnt lgkmcnt(4)
  v_mfma_f32_32x32x16_bf16 v[48:63], v[104:107], v[144:147], v[48:63]
  ds_read_b128 v[144:147], v151 offset:57344
  s_waitcnt lgkmcnt(4)
  v_mfma_f32_32x32x16_bf16 v[48:63], v[108:111], v[128:131], v[48:63]
  s_barrier
  ds_read_b128 v[128:131], v148 offset:61440
  ds_read_b64_tr_b16 v[112:113], v152 offset:16640
  ds_read_b64_tr_b16 v[114:115], v152 offset:16896
  s_waitcnt lgkmcnt(6)
  v_mfma_f32_32x32x16_bf16 v[64:79], v[96:99], v[132:135], v[64:79]
  ds_read_b128 v[132:135], v149 offset:61440
  ds_read_b64_tr_b16 v[116:117], v152 offset:17664
  ds_read_b64_tr_b16 v[118:119], v152 offset:17920
  s_waitcnt lgkmcnt(8)
  v_mfma_f32_32x32x16_bf16 v[64:79], v[100:103], v[136:139], v[64:79]
  ds_read_b128 v[136:139], v150 offset:61440
  ds_read_b64_tr_b16 v[120:121], v152 offset:18688
  ds_read_b64_tr_b16 v[122:123], v152 offset:18944
  s_waitcnt lgkmcnt(10)
  v_mfma_f32_32x32x16_bf16 v[64:79], v[104:107], v[140:143], v[64:79]
  ds_read_b128 v[140:143], v151 offset:61440
  ds_read_b64_tr_b16 v[124:125], v152 offset:19712
  ds_read_b64_tr_b16 v[126:127], v152 offset:19968
  s_waitcnt lgkmcnt(12)
  v_mfma_f32_32x32x16_bf16 v[64:79], v[108:111], v[144:147], v[64:79]
  v_xor_b32 v148, 0x10000, v148
  ds_read_b128 v[144:147], v148 offset:0
  s_waitcnt lgkmcnt(10)
  v_mfma_f32_32x32x16_bf16 v[0:15], v[112:115], v[128:131], v[0:15]
  v_xor_b32 v149, 0x10000, v149
  ds_read_b128 v[128:131], v149 offset:0
  s_waitcnt lgkmcnt(8)
  v_mfma_f32_32x32x16_bf16 v[0:15], v[116:119], v[132:135], v[0:15]
  v_xor_b32 v150, 0x10000, v150
  ds_read_b128 v[132:135], v150 offset:0
  s_waitcnt lgkmcnt(6)
  v_mfma_f32_32x32x16_bf16 v[0:15], v[120:123], v[136:139], v[0:15]
  v_xor_b32 v151, 0x10000, v151
  ds_read_b128 v[136:139], v151 offset:0
  s_waitcnt lgkmcnt(4)
  v_mfma_f32_32x32x16_bf16 v[0:15], v[124:127], v[140:143], v[0:15]
  ds_read_b128 v[140:143], v148 offset:4096
  s_waitcnt lgkmcnt(4)
  v_mfma_f32_32x32x16_bf16 v[16:31], v[112:115], v[144:147], v[16:31]
  ds_read_b128 v[144:147], v149 offset:4096
  s_waitcnt lgkmcnt(4)
  v_mfma_f32_32x32x16_bf16 v[16:31], v[116:119], v[128:131], v[16:31]
  ds_read_b128 v[128:131], v150 offset:4096
  s_waitcnt lgkmcnt(4)
  v_mfma_f32_32x32x16_bf16 v[16:31], v[120:123], v[132:135], v[16:31]
  ds_read_b128 v[132:135], v151 offset:4096
  s_waitcnt lgkmcnt(4)
  v_mfma_f32_32x32x16_bf16 v[16:31], v[124:127], v[136:139], v[16:31]
  ds_read_b128 v[136:139], v148 offset:8192
  s_waitcnt lgkmcnt(4)
  v_mfma_f32_32x32x16_bf16 v[32:47], v[112:115], v[140:143], v[32:47]
  ds_read_b128 v[140:143], v149 offset:8192
  s_waitcnt lgkmcnt(4)
  v_mfma_f32_32x32x16_bf16 v[32:47], v[116:119], v[144:147], v[32:47]
  ds_read_b128 v[144:147], v150 offset:8192
  s_waitcnt lgkmcnt(4)
  v_mfma_f32_32x32x16_bf16 v[32:47], v[120:123], v[128:131], v[32:47]
  ds_read_b128 v[128:131], v151 offset:8192
  s_waitcnt lgkmcnt(4)
  v_mfma_f32_32x32x16_bf16 v[32:47], v[124:127], v[132:135], v[32:47]
  ds_read_b128 v[132:135], v148 offset:12288
  s_waitcnt lgkmcnt(4)
  v_mfma_f32_32x32x16_bf16 v[48:63], v[112:115], v[136:139], v[48:63]
  ds_read_b128 v[136:139], v149 offset:12288
  s_waitcnt lgkmcnt(4)
  v_mfma_f32_32x32x16_bf16 v[48:63], v[116:119], v[140:143], v[48:63]
  ds_read_b128 v[140:143], v150 offset:12288
  s_waitcnt lgkmcnt(4)
  v_mfma_f32_32x32x16_bf16 v[48:63], v[120:123], v[144:147], v[48:63]
  ds_read_b128 v[144:147], v151 offset:12288
  s_waitcnt lgkmcnt(4)
  v_mfma_f32_32x32x16_bf16 v[48:63], v[124:127], v[128:131], v[48:63]
  s_barrier
  ds_read_b128 v[128:131], v148 offset:16384
  ds_read_b64_tr_b16 v[96:97], v152 offset:0
  ds_read_b64_tr_b16 v[98:99], v152 offset:256
  s_waitcnt lgkmcnt(6)
  v_mfma_f32_32x32x16_bf16 v[64:79], v[112:115], v[132:135], v[64:79]
  ds_read_b128 v[132:135], v149 offset:16384
  ds_read_b64_tr_b16 v[100:101], v152 offset:1024
  ds_read_b64_tr_b16 v[102:103], v152 offset:1280
  s_waitcnt lgkmcnt(8)
  v_mfma_f32_32x32x16_bf16 v[64:79], v[116:119], v[136:139], v[64:79]
  ds_read_b128 v[136:139], v150 offset:16384
  ds_read_b64_tr_b16 v[104:105], v152 offset:2048
  ds_read_b64_tr_b16 v[106:107], v152 offset:2304
  s_waitcnt lgkmcnt(10)
  v_mfma_f32_32x32x16_bf16 v[64:79], v[120:123], v[140:143], v[64:79]
  ds_read_b128 v[140:143], v151 offset:16384
  ds_read_b64_tr_b16 v[108:109], v152 offset:3072
  ds_read_b64_tr_b16 v[110:111], v152 offset:3328
  s_waitcnt lgkmcnt(12)
  v_mfma_f32_32x32x16_bf16 v[64:79], v[124:127], v[144:147], v[64:79]
  ds_read_b128 v[144:147], v148 offset:20480
  s_waitcnt lgkmcnt(10)
  v_mfma_f32_32x32x16_bf16 v[0:15], v[96:99], v[128:131], v[0:15]
  ds_read_b128 v[128:131], v149 offset:20480
  s_waitcnt lgkmcnt(8)
  v_mfma_f32_32x32x16_bf16 v[0:15], v[100:103], v[132:135], v[0:15]
  ds_read_b128 v[132:135], v150 offset:20480
  s_waitcnt lgkmcnt(6)
  v_mfma_f32_32x32x16_bf16 v[0:15], v[104:107], v[136:139], v[0:15]
  ds_read_b128 v[136:139], v151 offset:20480
  s_waitcnt lgkmcnt(4)
  v_mfma_f32_32x32x16_bf16 v[0:15], v[108:111], v[140:143], v[0:15]
  ds_read_b128 v[140:143], v148 offset:24576
  s_waitcnt lgkmcnt(4)
  v_mfma_f32_32x32x16_bf16 v[16:31], v[96:99], v[144:147], v[16:31]
  ds_read_b128 v[144:147], v149 offset:24576
  s_waitcnt lgkmcnt(4)
  v_mfma_f32_32x32x16_bf16 v[16:31], v[100:103], v[128:131], v[16:31]
  ds_read_b128 v[128:131], v150 offset:24576
  s_waitcnt lgkmcnt(4)
  v_mfma_f32_32x32x16_bf16 v[16:31], v[104:107], v[132:135], v[16:31]
  ds_read_b128 v[132:135], v151 offset:24576
  s_waitcnt lgkmcnt(4)
  v_mfma_f32_32x32x16_bf16 v[16:31], v[108:111], v[136:139], v[16:31]
  ds_read_b128 v[136:139], v148 offset:28672
  s_waitcnt lgkmcnt(4)
  v_mfma_f32_32x32x16_bf16 v[32:47], v[96:99], v[140:143], v[32:47]
  ds_read_b128 v[140:143], v149 offset:28672
  s_waitcnt lgkmcnt(4)
  v_mfma_f32_32x32x16_bf16 v[32:47], v[100:103], v[144:147], v[32:47]
  ds_read_b128 v[144:147], v150 offset:28672
  s_waitcnt lgkmcnt(4)
  v_mfma_f32_32x32x16_bf16 v[32:47], v[104:107], v[128:131], v[32:47]
  ds_read_b128 v[128:131], v151 offset:28672
  s_waitcnt lgkmcnt(4)
  v_mfma_f32_32x32x16_bf16 v[32:47], v[108:111], v[132:135], v[32:47]
  ds_read_b128 v[132:135], v148 offset:32768
  s_waitcnt lgkmcnt(4)
  v_mfma_f32_32x32x16_bf16 v[48:63], v[96:99], v[136:139], v[48:63]
  ds_read_b128 v[136:139], v149 offset:32768
  s_waitcnt lgkmcnt(4)
  v_mfma_f32_32x32x16_bf16 v[48:63], v[100:103], v[140:143], v[48:63]
  ds_read_b128 v[140:143], v150 offset:32768
  s_waitcnt lgkmcnt(4)
  v_mfma_f32_32x32x16_bf16 v[48:63], v[104:107], v[144:147], v[48:63]
  ds_read_b128 v[144:147], v151 offset:32768
  s_waitcnt lgkmcnt(4)
  v_mfma_f32_32x32x16_bf16 v[48:63], v[108:111], v[128:131], v[48:63]
  s_barrier
  ds_read_b128 v[128:131], v148 offset:36864
  ds_read_b64_tr_b16 v[112:113], v152 offset:16640
  ds_read_b64_tr_b16 v[114:115], v152 offset:16896
  s_waitcnt lgkmcnt(6)
  v_mfma_f32_32x32x16_bf16 v[64:79], v[96:99], v[132:135], v[64:79]
  ds_read_b128 v[132:135], v149 offset:36864
  ds_read_b64_tr_b16 v[116:117], v152 offset:17664
  ds_read_b64_tr_b16 v[118:119], v152 offset:17920
  s_waitcnt lgkmcnt(8)
  v_mfma_f32_32x32x16_bf16 v[64:79], v[100:103], v[136:139], v[64:79]
  ds_read_b128 v[136:139], v150 offset:36864
  ds_read_b64_tr_b16 v[120:121], v152 offset:18688
  ds_read_b64_tr_b16 v[122:123], v152 offset:18944
  s_waitcnt lgkmcnt(10)
  v_mfma_f32_32x32x16_bf16 v[64:79], v[104:107], v[140:143], v[64:79]
  ds_read_b128 v[140:143], v151 offset:36864
  ds_read_b64_tr_b16 v[124:125], v152 offset:19712
  ds_read_b64_tr_b16 v[126:127], v152 offset:19968
  s_waitcnt lgkmcnt(12)
  v_mfma_f32_32x32x16_bf16 v[64:79], v[108:111], v[144:147], v[64:79]
  ds_read_b128 v[144:147], v148 offset:40960
  s_waitcnt lgkmcnt(10)
  v_mfma_f32_32x32x16_bf16 v[0:15], v[112:115], v[128:131], v[0:15]
  ds_read_b128 v[128:131], v149 offset:40960
  s_waitcnt lgkmcnt(8)
  v_mfma_f32_32x32x16_bf16 v[0:15], v[116:119], v[132:135], v[0:15]
  ds_read_b128 v[132:135], v150 offset:40960
  s_waitcnt lgkmcnt(6)
  v_mfma_f32_32x32x16_bf16 v[0:15], v[120:123], v[136:139], v[0:15]
  ds_read_b128 v[136:139], v151 offset:40960
  s_waitcnt lgkmcnt(4)
  v_mfma_f32_32x32x16_bf16 v[0:15], v[124:127], v[140:143], v[0:15]
  ds_read_b128 v[140:143], v148 offset:45056
  s_waitcnt lgkmcnt(4)
  v_mfma_f32_32x32x16_bf16 v[16:31], v[112:115], v[144:147], v[16:31]
  ds_read_b128 v[144:147], v149 offset:45056
  s_waitcnt lgkmcnt(4)
  v_mfma_f32_32x32x16_bf16 v[16:31], v[116:119], v[128:131], v[16:31]
  ds_read_b128 v[128:131], v150 offset:45056
  s_waitcnt lgkmcnt(4)
  v_mfma_f32_32x32x16_bf16 v[16:31], v[120:123], v[132:135], v[16:31]
  ds_read_b128 v[132:135], v151 offset:45056
  s_waitcnt lgkmcnt(4)
  v_mfma_f32_32x32x16_bf16 v[16:31], v[124:127], v[136:139], v[16:31]
  ds_read_b128 v[136:139], v148 offset:49152
  s_waitcnt lgkmcnt(4)
  v_mfma_f32_32x32x16_bf16 v[32:47], v[112:115], v[140:143], v[32:47]
  ds_read_b128 v[140:143], v149 offset:49152
  s_waitcnt lgkmcnt(4)
  v_mfma_f32_32x32x16_bf16 v[32:47], v[116:119], v[144:147], v[32:47]
  ds_read_b128 v[144:147], v150 offset:49152
  s_waitcnt lgkmcnt(4)
  v_mfma_f32_32x32x16_bf16 v[32:47], v[120:123], v[128:131], v[32:47]
  ds_read_b128 v[128:131], v151 offset:49152
  s_waitcnt lgkmcnt(4)
  v_mfma_f32_32x32x16_bf16 v[32:47], v[124:127], v[132:135], v[32:47]
  ds_read_b128 v[132:135], v148 offset:53248
  s_waitcnt lgkmcnt(4)
  v_mfma_f32_32x32x16_bf16 v[48:63], v[112:115], v[136:139], v[48:63]
  ds_read_b128 v[136:139], v149 offset:53248
  s_waitcnt lgkmcnt(4)
  v_mfma_f32_32x32x16_bf16 v[48:63], v[116:119], v[140:143], v[48:63]
  ds_read_b128 v[140:143], v150 offset:53248
  s_waitcnt lgkmcnt(4)
  v_mfma_f32_32x32x16_bf16 v[48:63], v[120:123], v[144:147], v[48:63]
  ds_read_b128 v[144:147], v151 offset:53248
  s_waitcnt lgkmcnt(4)
  v_mfma_f32_32x32x16_bf16 v[48:63], v[124:127], v[128:131], v[48:63]
  s_barrier
  ds_read_b128 v[128:131], v148 offset:57344
  ds_read_b64_tr_b16 v[96:97], v152 offset:0
  ds_read_b64_tr_b16 v[98:99], v152 offset:256
  s_waitcnt lgkmcnt(6)
  v_mfma_f32_32x32x16_bf16 v[64:79], v[112:115], v[132:135], v[64:79]
  ds_read_b128 v[132:135], v149 offset:57344
  ds_read_b64_tr_b16 v[100:101], v152 offset:1024
  ds_read_b64_tr_b16 v[102:103], v152 offset:1280
  s_waitcnt lgkmcnt(8)
  v_mfma_f32_32x32x16_bf16 v[64:79], v[116:119], v[136:139], v[64:79]
  ds_read_b128 v[136:139], v150 offset:57344
  ds_read_b64_tr_b16 v[104:105], v152 offset:2048
  ds_read_b64_tr_b16 v[106:107], v152 offset:2304
  s_waitcnt lgkmcnt(10)
  v_mfma_f32_32x32x16_bf16 v[64:79], v[120:123], v[140:143], v[64:79]
  ds_read_b128 v[140:143], v151 offset:57344
  ds_read_b64_tr_b16 v[108:109], v152 offset:3072
  ds_read_b64_tr_b16 v[110:111], v152 offset:3328
  s_waitcnt lgkmcnt(12)
  v_mfma_f32_32x32x16_bf16 v[64:79], v[124:127], v[144:147], v[64:79]
  v_xor_b32 v148, 0x10000, v148
  ds_read_b128 v[144:147], v148 offset:0
  s_waitcnt lgkmcnt(10)
  v_mfma_f32_32x32x16_bf16 v[0:15], v[96:99], v[128:131], v[0:15]
  v_xor_b32 v149, 0x10000, v149
  ds_read_b128 v[128:131], v149 offset:0
  s_waitcnt lgkmcnt(8)
  v_mfma_f32_32x32x16_bf16 v[0:15], v[100:103], v[132:135], v[0:15]
  v_xor_b32 v150, 0x10000, v150
  ds_read_b128 v[132:135], v150 offset:0
  s_waitcnt lgkmcnt(6)
  v_mfma_f32_32x32x16_bf16 v[0:15], v[104:107], v[136:139], v[0:15]
  v_xor_b32 v151, 0x10000, v151
  ds_read_b128 v[136:139], v151 offset:0
  s_waitcnt lgkmcnt(4)
  v_mfma_f32_32x32x16_bf16 v[0:15], v[108:111], v[140:143], v[0:15]
  ds_read_b128 v[140:143], v148 offset:4096
  s_waitcnt lgkmcnt(4)
  v_mfma_f32_32x32x16_bf16 v[16:31], v[96:99], v[144:147], v[16:31]
  ds_read_b128 v[144:147], v149 offset:4096
  s_waitcnt lgkmcnt(4)
  v_mfma_f32_32x32x16_bf16 v[16:31], v[100:103], v[128:131], v[16:31]
  ds_read_b128 v[128:131], v150 offset:4096
  s_waitcnt lgkmcnt(4)
  v_mfma_f32_32x32x16_bf16 v[16:31], v[104:107], v[132:135], v[16:31]
  ds_read_b128 v[132:135], v151 offset:4096
  s_waitcnt lgkmcnt(4)
  v_mfma_f32_32x32x16_bf16 v[16:31], v[108:111], v[136:139], v[16:31]
  ds_read_b128 v[136:139], v148 offset:8192
  s_waitcnt lgkmcnt(4)
  v_mfma_f32_32x32x16_bf16 v[32:47], v[96:99], v[140:143], v[32:47]
  ds_read_b128 v[140:143], v149 offset:8192
  s_waitcnt lgkmcnt(4)
  v_mfma_f32_32x32x16_bf16 v[32:47], v[100:103], v[144:147], v[32:47]
  ds_read_b128 v[144:147], v150 offset:8192
  s_waitcnt lgkmcnt(4)
  v_mfma_f32_32x32x16_bf16 v[32:47], v[104:107], v[128:131], v[32:47]
  ds_read_b128 v[128:131], v151 offset:8192
  s_waitcnt lgkmcnt(4)
  v_mfma_f32_32x32x16_bf16 v[32:47], v[108:111], v[132:135], v[32:47]
  ds_read_b128 v[132:135], v148 offset:12288
  s_waitcnt lgkmcnt(4)
  v_mfma_f32_32x32x16_bf16 v[48:63], v[96:99], v[136:139], v[48:63]
  ds_read_b128 v[136:139], v149 offset:12288
  s_waitcnt lgkmcnt(4)
  v_mfma_f32_32x32x16_bf16 v[48:63], v[100:103], v[140:143], v[48:63]
  ds_read_b128 v[140:143], v150 offset:12288
  s_waitcnt lgkmcnt(4)
  v_mfma_f32_32x32x16_bf16 v[48:63], v[104:107], v[144:147], v[48:63]
  ds_read_b128 v[144:147], v151 offset:12288
  s_waitcnt lgkmcnt(4)
  v_mfma_f32_32x32x16_bf16 v[48:63], v[108:111], v[128:131], v[48:63]
  s_barrier
  ds_read_b128 v[128:131], v148 offset:16384
  ds_read_b64_tr_b16 v[112:113], v152 offset:16640
  ds_read_b64_tr_b16 v[114:115], v152 offset:16896
  s_waitcnt lgkmcnt(6)
  v_mfma_f32_32x32x16_bf16 v[64:79], v[96:99], v[132:135], v[64:79]
  ds_read_b128 v[132:135], v149 offset:16384
  ds_read_b64_tr_b16 v[116:117], v152 offset:17664
  ds_read_b64_tr_b16 v[118:119], v152 offset:17920
  s_waitcnt lgkmcnt(8)
  v_mfma_f32_32x32x16_bf16 v[64:79], v[100:103], v[136:139], v[64:79]
  ds_read_b128 v[136:139], v150 offset:16384
  ds_read_b64_tr_b16 v[120:121], v152 offset:18688
  ds_read_b64_tr_b16 v[122:123], v152 offset:18944
  s_waitcnt lgkmcnt(10)
  v_mfma_f32_32x32x16_bf16 v[64:79], v[104:107], v[140:143], v[64:79]
  ds_read_b128 v[140:143], v151 offset:16384
  ds_read_b64_tr_b16 v[124:125], v152 offset:19712
  ds_read_b64_tr_b16 v[126:127], v152 offset:19968
  s_waitcnt lgkmcnt(12)
  v_mfma_f32_32x32x16_bf16 v[64:79], v[108:111], v[144:147], v[64:79]
  ds_read_b128 v[144:147], v148 offset:20480
  s_waitcnt lgkmcnt(10)
  v_mfma_f32_32x32x16_bf16 v[0:15], v[112:115], v[128:131], v[0:15]
  ds_read_b128 v[128:131], v149 offset:20480
  s_waitcnt lgkmcnt(8)
  v_mfma_f32_32x32x16_bf16 v[0:15], v[116:119], v[132:135], v[0:15]
  ds_read_b128 v[132:135], v150 offset:20480
  s_waitcnt lgkmcnt(6)
  v_mfma_f32_32x32x16_bf16 v[0:15], v[120:123], v[136:139], v[0:15]
  ds_read_b128 v[136:139], v151 offset:20480
  s_waitcnt lgkmcnt(4)
  v_mfma_f32_32x32x16_bf16 v[0:15], v[124:127], v[140:143], v[0:15]
  ds_read_b128 v[140:143], v148 offset:24576
  s_waitcnt lgkmcnt(4)
  v_mfma_f32_32x32x16_bf16 v[16:31], v[112:115], v[144:147], v[16:31]
  ds_read_b128 v[144:147], v149 offset:24576
  s_waitcnt lgkmcnt(4)
  v_mfma_f32_32x32x16_bf16 v[16:31], v[116:119], v[128:131], v[16:31]
  ds_read_b128 v[128:131], v150 offset:24576
  s_waitcnt lgkmcnt(4)
  v_mfma_f32_32x32x16_bf16 v[16:31], v[120:123], v[132:135], v[16:31]
  ds_read_b128 v[132:135], v151 offset:24576
  s_waitcnt lgkmcnt(4)
  v_mfma_f32_32x32x16_bf16 v[16:31], v[124:127], v[136:139], v[16:31]
  ds_read_b128 v[136:139], v148 offset:28672
  s_waitcnt lgkmcnt(4)
  v_mfma_f32_32x32x16_bf16 v[32:47], v[112:115], v[140:143], v[32:47]
  ds_read_b128 v[140:143], v149 offset:28672
  s_waitcnt lgkmcnt(4)
  v_mfma_f32_32x32x16_bf16 v[32:47], v[116:119], v[144:147], v[32:47]
  ds_read_b128 v[144:147], v150 offset:28672
  s_waitcnt lgkmcnt(4)
  v_mfma_f32_32x32x16_bf16 v[32:47], v[120:123], v[128:131], v[32:47]
  ds_read_b128 v[128:131], v151 offset:28672
  s_waitcnt lgkmcnt(4)
  v_mfma_f32_32x32x16_bf16 v[32:47], v[124:127], v[132:135], v[32:47]
  ds_read_b128 v[132:135], v148 offset:32768
  s_waitcnt lgkmcnt(4)
  v_mfma_f32_32x32x16_bf16 v[48:63], v[112:115], v[136:139], v[48:63]
  ds_read_b128 v[136:139], v149 offset:32768
  s_waitcnt lgkmcnt(4)
  v_mfma_f32_32x32x16_bf16 v[48:63], v[116:119], v[140:143], v[48:63]
  ds_read_b128 v[140:143], v150 offset:32768
  s_waitcnt lgkmcnt(4)
  v_mfma_f32_32x32x16_bf16 v[48:63], v[120:123], v[144:147], v[48:63]
  ds_read_b128 v[144:147], v151 offset:32768
  s_waitcnt lgkmcnt(4)
  v_mfma_f32_32x32x16_bf16 v[48:63], v[124:127], v[128:131], v[48:63]
  s_barrier
  ds_read_b128 v[128:131], v148 offset:36864
  ds_read_b64_tr_b16 v[96:97], v152 offset:0
  ds_read_b64_tr_b16 v[98:99], v152 offset:256
  s_waitcnt lgkmcnt(6)
  v_mfma_f32_32x32x16_bf16 v[64:79], v[112:115], v[132:135], v[64:79]
  ds_read_b128 v[132:135], v149 offset:36864
  ds_read_b64_tr_b16 v[100:101], v152 offset:1024
  ds_read_b64_tr_b16 v[102:103], v152 offset:1280
  s_waitcnt lgkmcnt(8)
  v_mfma_f32_32x32x16_bf16 v[64:79], v[116:119], v[136:139], v[64:79]
  ds_read_b128 v[136:139], v150 offset:36864
  ds_read_b64_tr_b16 v[104:105], v152 offset:2048
  ds_read_b64_tr_b16 v[106:107], v152 offset:2304
  s_waitcnt lgkmcnt(10)
  v_mfma_f32_32x32x16_bf16 v[64:79], v[120:123], v[140:143], v[64:79]
  ds_read_b128 v[140:143], v151 offset:36864
  ds_read_b64_tr_b16 v[108:109], v152 offset:3072
  ds_read_b64_tr_b16 v[110:111], v152 offset:3328
  s_waitcnt lgkmcnt(12)
  v_mfma_f32_32x32x16_bf16 v[64:79], v[124:127], v[144:147], v[64:79]
  ds_read_b128 v[144:147], v148 offset:40960
  s_waitcnt lgkmcnt(10)
  v_mfma_f32_32x32x16_bf16 v[0:15], v[96:99], v[128:131], v[0:15]
  ds_read_b128 v[128:131], v149 offset:40960
  s_waitcnt lgkmcnt(8)
  v_mfma_f32_32x32x16_bf16 v[0:15], v[100:103], v[132:135], v[0:15]
  ds_read_b128 v[132:135], v150 offset:40960
  s_waitcnt lgkmcnt(6)
  v_mfma_f32_32x32x16_bf16 v[0:15], v[104:107], v[136:139], v[0:15]
  ds_read_b128 v[136:139], v151 offset:40960
  s_waitcnt lgkmcnt(4)
  v_mfma_f32_32x32x16_bf16 v[0:15], v[108:111], v[140:143], v[0:15]
  ds_read_b128 v[140:143], v148 offset:45056
  s_waitcnt lgkmcnt(4)
  v_mfma_f32_32x32x16_bf16 v[16:31], v[96:99], v[144:147], v[16:31]
  ds_read_b128 v[144:147], v149 offset:45056
  s_waitcnt lgkmcnt(4)
  v_mfma_f32_32x32x16_bf16 v[16:31], v[100:103], v[128:131], v[16:31]
  ds_read_b128 v[128:131], v150 offset:45056
  s_waitcnt lgkmcnt(4)
  v_mfma_f32_32x32x16_bf16 v[16:31], v[104:107], v[132:135], v[16:31]
  ds_read_b128 v[132:135], v151 offset:45056
  s_waitcnt lgkmcnt(4)
  v_mfma_f32_32x32x16_bf16 v[16:31], v[108:111], v[136:139], v[16:31]
  ds_read_b128 v[136:139], v148 offset:49152
  s_waitcnt lgkmcnt(4)
  v_mfma_f32_32x32x16_bf16 v[32:47], v[96:99], v[140:143], v[32:47]
  ds_read_b128 v[140:143], v149 offset:49152
  s_waitcnt lgkmcnt(4)
  v_mfma_f32_32x32x16_bf16 v[32:47], v[100:103], v[144:147], v[32:47]
  ds_read_b128 v[144:147], v150 offset:49152
  s_waitcnt lgkmcnt(4)
  v_mfma_f32_32x32x16_bf16 v[32:47], v[104:107], v[128:131], v[32:47]
  ds_read_b128 v[128:131], v151 offset:49152
  s_waitcnt lgkmcnt(4)
  v_mfma_f32_32x32x16_bf16 v[32:47], v[108:111], v[132:135], v[32:47]
  ds_read_b128 v[132:135], v148 offset:53248
  s_waitcnt lgkmcnt(4)
  v_mfma_f32_32x32x16_bf16 v[48:63], v[96:99], v[136:139], v[48:63]
  ds_read_b128 v[136:139], v149 offset:53248
  s_waitcnt lgkmcnt(4)
  v_mfma_f32_32x32x16_bf16 v[48:63], v[100:103], v[140:143], v[48:63]
  ds_read_b128 v[140:143], v150 offset:53248
  s_waitcnt lgkmcnt(4)
  v_mfma_f32_32x32x16_bf16 v[48:63], v[104:107], v[144:147], v[48:63]
  ds_read_b128 v[144:147], v151 offset:53248
  s_waitcnt lgkmcnt(4)
  v_mfma_f32_32x32x16_bf16 v[48:63], v[108:111], v[128:131], v[48:63]
  s_barrier
  ds_read_b128 v[128:131], v148 offset:57344
  ds_read_b64_tr_b16 v[112:113], v152 offset:16640
  ds_read_b64_tr_b16 v[114:115], v152 offset:16896
  s_waitcnt lgkmcnt(6)
  v_mfma_f32_32x32x16_bf16 v[64:79], v[96:99], v[132:135], v[64:79]
  ds_read_b128 v[132:135], v149 offset:57344
  ds_read_b64_tr_b16 v[116:117], v152 offset:17664
  ds_read_b64_tr_b16 v[118:119], v152 offset:17920
  s_waitcnt lgkmcnt(8)
  v_mfma_f32_32x32x16_bf16 v[64:79], v[100:103], v[136:139], v[64:79]
  ds_read_b128 v[136:139], v150 offset:57344
  ds_read_b64_tr_b16 v[120:121], v152 offset:18688
  ds_read_b64_tr_b16 v[122:123], v152 offset:18944
  s_waitcnt lgkmcnt(10)
  v_mfma_f32_32x32x16_bf16 v[64:79], v[104:107], v[140:143], v[64:79]
  ds_read_b128 v[140:143], v151 offset:57344
  ds_read_b64_tr_b16 v[124:125], v152 offset:19712
  ds_read_b64_tr_b16 v[126:127], v152 offset:19968
  s_waitcnt lgkmcnt(12)
  v_mfma_f32_32x32x16_bf16 v[64:79], v[108:111], v[144:147], v[64:79]
  ds_read_b128 v[144:147], v148 offset:61440
  s_waitcnt lgkmcnt(10)
  v_mfma_f32_32x32x16_bf16 v[0:15], v[112:115], v[128:131], v[0:15]
  ds_read_b128 v[128:131], v149 offset:61440
  s_waitcnt lgkmcnt(8)
  v_mfma_f32_32x32x16_bf16 v[0:15], v[116:119], v[132:135], v[0:15]
  ds_read_b128 v[132:135], v150 offset:61440
  s_waitcnt lgkmcnt(6)
  v_mfma_f32_32x32x16_bf16 v[0:15], v[120:123], v[136:139], v[0:15]
  ds_read_b128 v[136:139], v151 offset:61440
  s_waitcnt lgkmcnt(4)
  v_mfma_f32_32x32x16_bf16 v[0:15], v[124:127], v[140:143], v[0:15]
  v_xor_b32 v148, 0x10000, v148
  ds_read_b128 v[140:143], v148 offset:0
  s_waitcnt lgkmcnt(4)
  v_mfma_f32_32x32x16_bf16 v[16:31], v[112:115], v[144:147], v[16:31]
  v_xor_b32 v149, 0x10000, v149
  ds_read_b128 v[144:147], v149 offset:0
  s_waitcnt lgkmcnt(4)
  v_mfma_f32_32x32x16_bf16 v[16:31], v[116:119], v[128:131], v[16:31]
  v_xor_b32 v150, 0x10000, v150
  ds_read_b128 v[128:131], v150 offset:0
  v_cvt_pk_bf16_f32 v0, v0, v1
  v_cvt_pk_bf16_f32 v1, v2, v3
  v_cvt_pk_bf16_f32 v2, v4, v5
  v_cvt_pk_bf16_f32 v3, v6, v7
  v_cvt_pk_bf16_f32 v4, v8, v9
  v_cvt_pk_bf16_f32 v5, v10, v11
  v_permlane32_swap_b32 v0, v2
  v_permlane32_swap_b32 v1, v3
  s_waitcnt lgkmcnt(4)
  v_mfma_f32_32x32x16_bf16 v[16:31], v[120:123], v[132:135], v[16:31]
  v_xor_b32 v151, 0x10000, v151
  ds_read_b128 v[132:135], v151 offset:0
  v_cvt_pk_bf16_f32 v6, v12, v13
  ds_write_b128 v154, v[0:3] offset:0
  v_cvt_pk_bf16_f32 v7, v14, v15
  v_xor_b32 v8, 32, v154
  s_nop 0
  v_permlane32_swap_b32 v4, v6
  v_permlane32_swap_b32 v5, v7
  ds_write_b128 v8, v[4:7] offset:0
  s_waitcnt lgkmcnt(6)
  v_mfma_f32_32x32x16_bf16 v[16:31], v[124:127], v[136:139], v[16:31]
  ds_read_b128 v[136:139], v148 offset:4096
  ds_write_b8 v153, v155 offset:0
  s_waitcnt lgkmcnt(7)
  v_mfma_f32_32x32x16_bf16 v[32:47], v[112:115], v[140:143], v[32:47]
  ds_read_b128 v[140:143], v149 offset:4096
  s_waitcnt lgkmcnt(7)
  v_mfma_f32_32x32x16_bf16 v[32:47], v[116:119], v[144:147], v[32:47]
  ds_read_b128 v[144:147], v150 offset:4096
  v_cvt_pk_bf16_f32 v16, v16, v17
  v_cvt_pk_bf16_f32 v17, v18, v19
  v_cvt_pk_bf16_f32 v18, v20, v21
  v_cvt_pk_bf16_f32 v19, v22, v23
  v_cvt_pk_bf16_f32 v20, v24, v25
  v_cvt_pk_bf16_f32 v21, v26, v27
  v_permlane32_swap_b32 v16, v18
  v_permlane32_swap_b32 v17, v19
  s_waitcnt lgkmcnt(7)
  v_mfma_f32_32x32x16_bf16 v[32:47], v[120:123], v[128:131], v[32:47]
  ds_read_b128 v[128:131], v151 offset:4096
  v_cvt_pk_bf16_f32 v22, v28, v29
  ds_write_b128 v154, v[16:19] offset:2048
  v_cvt_pk_bf16_f32 v23, v30, v31
  v_xor_b32 v24, 32, v154
  s_nop 0
  v_permlane32_swap_b32 v20, v22
  v_permlane32_swap_b32 v21, v23
  ds_write_b128 v24, v[20:23] offset:2048
  s_waitcnt lgkmcnt(9)
  v_mfma_f32_32x32x16_bf16 v[32:47], v[124:127], v[132:135], v[32:47]
  ds_read_b128 v[132:135], v148 offset:8192
  ds_write_b8 v153, v155 offset:4
  s_waitcnt lgkmcnt(8)
  v_mfma_f32_32x32x16_bf16 v[48:63], v[112:115], v[136:139], v[48:63]
  ds_read_b128 v[136:139], v149 offset:8192
  s_waitcnt lgkmcnt(7)
  v_mfma_f32_32x32x16_bf16 v[48:63], v[116:119], v[140:143], v[48:63]
  ds_read_b128 v[140:143], v150 offset:8192
  v_cvt_pk_bf16_f32 v32, v32, v33
  v_cvt_pk_bf16_f32 v33, v34, v35
  v_cvt_pk_bf16_f32 v34, v36, v37
  v_cvt_pk_bf16_f32 v35, v38, v39
  v_cvt_pk_bf16_f32 v36, v40, v41
  v_cvt_pk_bf16_f32 v37, v42, v43
  v_permlane32_swap_b32 v32, v34
  v_permlane32_swap_b32 v33, v35
  s_waitcnt lgkmcnt(7)
  v_mfma_f32_32x32x16_bf16 v[48:63], v[120:123], v[144:147], v[48:63]
  ds_read_b128 v[144:147], v151 offset:8192
  v_cvt_pk_bf16_f32 v38, v44, v45
  ds_write_b128 v154, v[32:35] offset:16640
  v_cvt_pk_bf16_f32 v39, v46, v47
  v_xor_b32 v40, 32, v154
  s_nop 0
  v_permlane32_swap_b32 v36, v38
  v_permlane32_swap_b32 v37, v39
  ds_write_b128 v40, v[36:39] offset:16640
  s_waitcnt lgkmcnt(9)
  v_mfma_f32_32x32x16_bf16 v[48:63], v[124:127], v[128:131], v[48:63]
  ds_write_b8 v153, v155 offset:8
  s_waitcnt lgkmcnt(7)
  v_mfma_f32_32x32x16_bf16 v[64:79], v[112:115], v[132:135], v[64:79]
  s_waitcnt lgkmcnt(5)
  v_mfma_f32_32x32x16_bf16 v[64:79], v[116:119], v[136:139], v[64:79]
  v_cvt_pk_bf16_f32 v48, v48, v49
  v_cvt_pk_bf16_f32 v49, v50, v51
  v_cvt_pk_bf16_f32 v50, v52, v53
  v_cvt_pk_bf16_f32 v51, v54, v55
  v_cvt_pk_bf16_f32 v52, v56, v57
  v_cvt_pk_bf16_f32 v53, v58, v59
  v_permlane32_swap_b32 v48, v50
  v_permlane32_swap_b32 v49, v51
  s_waitcnt lgkmcnt(4)
  v_mfma_f32_32x32x16_bf16 v[64:79], v[120:123], v[140:143], v[64:79]
  v_cvt_pk_bf16_f32 v54, v60, v61
  ds_write_b128 v154, v[48:51] offset:18688
  v_cvt_pk_bf16_f32 v55, v62, v63
  v_xor_b32 v56, 32, v154
  s_nop 0
  v_permlane32_swap_b32 v52, v54
  v_permlane32_swap_b32 v53, v55
  ds_write_b128 v56, v[52:55] offset:18688
  s_waitcnt lgkmcnt(5)
  v_mfma_f32_32x32x16_bf16 v[64:79], v[124:127], v[144:147], v[64:79]
  ds_write_b8 v153, v155 offset:12
  s_nop 10
  v_cvt_pk_bf16_f32 v64, v64, v65
  v_subrev_u32 v154, 126976, v154
  v_cvt_pk_bf16_f32 v65, v66, v67
  v_cvt_pk_bf16_f32 v66, v68, v69
  v_cvt_pk_bf16_f32 v67, v70, v71
  v_cvt_pk_bf16_f32 v68, v72, v73
  v_cvt_pk_bf16_f32 v69, v74, v75
  v_permlane32_swap_b32 v64, v66
  v_permlane32_swap_b32 v65, v67
  v_cvt_pk_bf16_f32 v70, v76, v77
  ds_write_b128 v154, v[64:67] offset:0
  v_cvt_pk_bf16_f32 v71, v78, v79
  v_xor_b32 v72, 32, v154
  s_nop 0
  v_permlane32_swap_b32 v68, v70
  v_permlane32_swap_b32 v69, v71
  ds_write_b128 v72, v[68:71] offset:0
  ds_write_b8 v153, v155 offset:16
  s_endpgm
L_last:
  s_endpgm
.section .rodata,"a"
.p2align 6
.amdhsa_kernel standalone__structured_sparse_n_m__ragged_kernel
  .amdhsa_next_free_vgpr 168
  .amdhsa_next_free_sgpr 100
  .amdhsa_accum_offset 168
  .amdhsa_group_segment_fixed_size 0
  .amdhsa_kernarg_size 48
  .amdhsa_user_sgpr_count 2
  .amdhsa_user_sgpr_kernarg_segment_ptr 1
  .amdhsa_system_sgpr_workgroup_id_x 1
.end_amdhsa_kernel
```
